```python
import torch

def _softmax(x, axis=-1):
    return torch.softmax(x, dim=axis)
def _gelu(x):
    return torch.nn.functional.gelu(x, approximate="tanh")
def _silu(x):
    return torch.nn.functional.silu(x)
def _sigmoid(x):
    return torch.sigmoid(x)
def _layernorm(x, axis=-1, eps=1e-5):
    m = x.mean(dim=axis, keepdim=True)
    v = x.var(dim=axis, keepdim=True, unbiased=False)
    return (x - m) / torch.sqrt(v + eps)
def _scatter_add(tgt, idx, src, axis=0):
    return tgt.clone().index_add_(axis, idx, src)
def _segment_sum(src, seg, n):
    out = torch.zeros((n,) + src.shape[1:], dtype=src.dtype)
    return out.index_add_(0, seg, src)
def _pad(x, pw):
    flat = tuple(v for pair in reversed(pw) for v in pair)
    return torch.nn.functional.pad(x, flat)

kernel_name = 'sequential_preLN__gqa_block_cached__dense_activation_silu__decode'

def setup_inputs():

    _w = (lambda a: (lambda t: t.to(torch.bfloat16) if t.is_floating_point() else t)(torch.as_tensor(a)))
    def _A_setup():
        B, Sq, D = 2, 1, 1024
        Hq, Hkv, Sk, Dh = 32, 4, 16384, 128
        assert Hq % Hkv == 0, (Hq, Hkv)
        return {
            "x": _w((lambda *s: torch.randn(*s, dtype=torch.bfloat16) * 0.1)(B, Sq, D)),
            "k_cache": _w((lambda *s: torch.randn(*s, dtype=torch.bfloat16) * 1.6)(B, Hkv, Sk, Dh)),
            "v_cache": _w((lambda *s: torch.randn(*s, dtype=torch.bfloat16) * 1.6)(B, Hkv, Sk, Dh)),
            "wq": _w((lambda *s: torch.randn(*s, dtype=torch.bfloat16) * 1.6)(D, Hq * Dh) * (D ** -0.5)),
            "wo": _w((lambda *s: torch.randn(*s, dtype=torch.bfloat16) * 1.6)(Hq * Dh, D) * ((Hq * Dh) ** -0.5)),
        }
    _A_in = _A_setup()

    def _B_setup():
        B, S, D, F = 2, 1, 1024, 3584
        return {
            "x": _w((lambda *s: torch.randn(*s, dtype=torch.bfloat16) * 0.1)(B, S, D)),
            "w1": _w((lambda *s: torch.randn(*s, dtype=torch.bfloat16) * 3.2)(D, F) * (D ** -0.5)),
            "w2": _w((lambda *s: torch.randn(*s, dtype=torch.bfloat16) * 3.2)(F, D) * (F ** -0.5)),
        }
    _B_in = _B_setup()

    return {
        "A_x": _A_in["x"],
        "A_k_cache": _A_in["k_cache"],
        "A_v_cache": _A_in["v_cache"],
        "A_wq": _A_in["wq"],
        "A_wo": _A_in["wo"],
        "B_x": _B_in["x"],
        "B_w1": _B_in["w1"],
        "B_w2": _B_in["w2"],
    }

def reference(A_x, A_k_cache, A_v_cache, A_wq, A_wo, B_x, B_w1, B_w2):
    def _A_ref(x, k_cache, v_cache, wq, wo):
        B, Sq, D = x.shape
        Hq, Dh = 32, 128
        Hkv = k_cache.shape[1]
        rep = Hq // Hkv
        q = (lambda x, *d: x.permute(*d))((x @ wq).reshape(B, Sq, Hq, Dh), 0, 2, 1, 3)
        k = (lambda x, n, axis: torch.repeat_interleave(x, n, dim=axis))(k_cache, rep, axis=1)
        v = (lambda x, n, axis: torch.repeat_interleave(x, n, dim=axis))(v_cache, rep, axis=1)
        scores = torch.einsum("bhqd,bhkd->bhqk", q, k) * (Dh ** -0.5)
        p = _softmax(scores, axis=-1)
        o = torch.einsum("bhqk,bhkd->bhqd", p, v)
        return (lambda x, *d: x.permute(*d))(o, 0, 2, 1, 3).reshape(B, Sq, Hq * Dh) @ wo

    def _B_ref(x, w1, w2):
        h = torch.einsum("bsd,df->bsf", x, w1)
        h = _silu(h)
        out = torch.einsum("bsf,fd->bsd", h, w2)
        return out

    x = A_x
    h = x + _A_ref(_layernorm(x, axis=-1), A_k_cache, A_v_cache, A_wq, A_wo)
    h2 = h + _B_ref(_layernorm(h, axis=-1), B_w1, B_w2)
    return h2
```

```asm
; @launch grid=(256,1,1) block=(768,1,1) lds=139264
.amdgcn_target "amdgcn-amd-amdhsa--gfx950"
.text
.globl sequential_preLN__gqa_block_cached__dense_activation_silu__decode_kernel
.p2align 8
.type sequential_preLN__gqa_block_cached__dense_activation_silu__decode_kernel,@function
sequential_preLN__gqa_block_cached__dense_activation_silu__decode_kernel:

    s_cmp_ge_u32 s2, 256
    s_cbranch_scc1 L_end

    s_load_dwordx8 s[4:11], s[0:1], 0
    s_load_dwordx2 s[12:13], s[0:1], 32
    s_load_dwordx4 s[16:19], s[0:1], 48
    s_load_dwordx4 s[20:23], s[0:1], 64
    s_load_dwordx2 s[24:25], s[0:1], 80
    v_lshrrev_b32 v1, 6, v0
    v_and_b32 v0, 63, v0
    s_mov_b32 s37, 0x05040100
    v_readfirstlane_b32 s26, v1
    s_mov_b32 s38, 0x07060302
    s_mov_b32 s33, 0x07060500
    s_mov_b32 s34, 0x07060501
    s_mov_b32 s35, 0x07060502
    s_mov_b32 s36, 0x07060503
    s_mov_b64 s[14:15], -1
    v_lshrrev_b32 v2, 4, v0
    v_and_b32 v3, 15, v0
    s_cmp_ge_u32 s26, 4
    s_cbranch_scc1 L_A

    s_setprio 3
    s_mov_b32 s27, s26
    v_bfe_u32 v4, v3, 2, 1
    v_and_b32 v5, 3, v3
    v_lshrrev_b32 v7, 3, v3
    v_lshl_or_b32 v5, v7, 2, v5
    s_and_b32 s52, s2, 6
    s_lshr_b32 s53, s2, 3
    v_mov_b32 v7, 0
    v_lshl_add_u32 v8, v5, 2, v2
    v_lshlrev_b32 v8, 4, v8
    v_lshl_add_u32 v8, v4, 11, v8
    s_lshl_b32 s61, s52, 8
    s_lshl_b32 s62, s27, 6
    s_add_u32 s61, s61, s62
    v_lshlrev_b32 v9, 3, v2
    v_lshl_add_u32 v9, v4, 11, v9
    v_add_u32 v9, s61, v9
    s_lshl_b32 s61, s52, 7
    s_lshl_b32 s62, s27, 5
    s_add_u32 s61, s61, s62
    s_lshl_b32 s61, s61, 13
    s_lshl_b32 s62, s53, 8
    s_add_u32 s61, s61, s62
    v_lshlrev_b32 v10, 15, v2
    v_lshl_add_u32 v10, v3, 4, v10
    s_waitcnt lgkmcnt(0)
    s_add_u32 s44, s10, s61
    s_addc_u32 s45, s11, 0
    global_load_dword v6, v7, s[24:25] sc1

s_bitcmp1_b32 s2, 0
 s_cbranch_scc1 L_qx1
global_load_dwordx4 v[120:123], v8, s[4:5] offset:0
global_load_dwordx4 v[124:127], v8, s[4:5] offset:512
global_load_dwordx4 v[128:131], v8, s[4:5] offset:1024
global_load_dwordx4 v[132:135], v8, s[4:5] offset:1536
global_load_dwordx2 v[12:13], v9, s[4:5]
global_load_dwordx2 v[14:15], v9, s[4:5] offset:32
global_load_dwordx2 v[136:137], v9, s[4:5] offset:256
 global_load_dwordx2 v[138:139], v9, s[4:5] offset:288
s_add_u32 s46, s44, 1048576
 s_addc_u32 s47, s45, 0
global_load_dwordx4 v[24:27], v10, s[44:45] nt
s_add_u32 s44, s44, 8192
 s_addc_u32 s45, s45, 0
global_load_dwordx4 v[28:31], v10, s[44:45] nt
s_add_u32 s44, s44, 8192
 s_addc_u32 s45, s45, 0
global_load_dwordx4 v[32:35], v10, s[44:45] nt
s_add_u32 s44, s44, 8192
 s_addc_u32 s45, s45, 0
global_load_dwordx4 v[36:39], v10, s[44:45] nt
s_add_u32 s44, s44, 106496
 s_addc_u32 s45, s45, 0
global_load_dwordx4 v[40:43], v10, s[44:45] nt
s_add_u32 s44, s44, 8192
 s_addc_u32 s45, s45, 0
global_load_dwordx4 v[44:47], v10, s[44:45] nt
s_add_u32 s44, s44, 8192
 s_addc_u32 s45, s45, 0
global_load_dwordx4 v[48:51], v10, s[44:45] nt
s_add_u32 s44, s44, 8192
 s_addc_u32 s45, s45, 0
global_load_dwordx4 v[52:55], v10, s[44:45] nt
global_load_dwordx4 v[56:59], v10, s[46:47] nt
s_add_u32 s46, s46, 8192
 s_addc_u32 s47, s47, 0
global_load_dwordx4 v[60:63], v10, s[46:47] nt
s_add_u32 s46, s46, 8192
 s_addc_u32 s47, s47, 0
global_load_dwordx4 v[64:67], v10, s[46:47] nt
s_add_u32 s46, s46, 8192
 s_addc_u32 s47, s47, 0
global_load_dwordx4 v[68:71], v10, s[46:47] nt
s_add_u32 s46, s46, 106496
 s_addc_u32 s47, s47, 0
global_load_dwordx4 v[72:75], v10, s[46:47] nt
s_add_u32 s46, s46, 8192
 s_addc_u32 s47, s47, 0
global_load_dwordx4 v[76:79], v10, s[46:47] nt
s_add_u32 s46, s46, 8192
 s_addc_u32 s47, s47, 0
global_load_dwordx4 v[80:83], v10, s[46:47] nt
s_add_u32 s46, s46, 8192
 s_addc_u32 s47, s47, 0
global_load_dwordx4 v[84:87], v10, s[46:47] nt
L_qx1:

    s_mov_b32 s40, 0
    s_mov_b32 s41, -1
    s_mov_b32 s48, 0xf0f0f0f0
    s_mov_b32 s49, 0xf0f0f0f0
    s_mov_b32 s50, 0x22222222
    s_mov_b32 s51, 0x22222222
    v_mov_b32 v20, 0
    v_mov_b32 v21, 0
    v_mov_b32 v22, 0
    v_mov_b32 v23, 0
    s_lshl_b32 s61, s27, 10
    v_lshl_add_u32 v7, v0, 4, s61
    ds_write_b128 v7, v[20:23] offset:2816
    v_and_b32 v8, 1, v0
    v_lshlrev_b32 v8, 4, v8
    ds_write_b128 v8, v[20:23] offset:6912
    s_waitcnt lgkmcnt(0)
    s_barrier
    v_lshrrev_b32 v10, 1, v2
    v_lshl_add_u32 v10, v3, 1, v10
    v_lshlrev_b32 v10, 4, v10

s_bitcmp1_b32 s2, 0
 s_cbranch_scc0 L_qy2
s_waitcnt vmcnt(0)

        v_readfirstlane_b32 s28, v6
        s_add_u32 s28, s28, 0x01010101
        s_or_b32 s28, s28, 1
        s_mov_b32 s29, s28
        s_lshr_b32 s30, s28, 8
        s_lshr_b32 s31, s28, 16
        s_lshr_b32 s32, s28, 24
        v_mov_b32 v6, s28

s_branch L_q_nored
 L_qy2:
s_waitcnt vmcnt(16)

        v_readfirstlane_b32 s28, v6
        s_add_u32 s28, s28, 0x01010101
        s_or_b32 s28, s28, 1
        s_mov_b32 s29, s28
        s_lshr_b32 s30, s28, 8
        s_lshr_b32 s31, s28, 16
        s_lshr_b32 s32, s28, 24
        v_mov_b32 v6, s28

v_lshlrev_b32 v92, 16, v120
 v_and_b32 v93, 0xffff0000, v120
v_mov_b32 v88, v92
 v_mov_b32 v89, v93
 v_mul_f32 v90, v92, v92
 v_mul_f32 v91, v93, v93
v_lshlrev_b32 v92, 16, v121
 v_and_b32 v93, 0xffff0000, v121
v_add_f32 v88, v88, v92
 v_add_f32 v89, v89, v93
 v_fmac_f32 v90, v92, v92
 v_fmac_f32 v91, v93, v93
v_lshlrev_b32 v92, 16, v122
 v_and_b32 v93, 0xffff0000, v122
v_add_f32 v88, v88, v92
 v_add_f32 v89, v89, v93
 v_fmac_f32 v90, v92, v92
 v_fmac_f32 v91, v93, v93
v_lshlrev_b32 v92, 16, v123
 v_and_b32 v93, 0xffff0000, v123
v_add_f32 v88, v88, v92
 v_add_f32 v89, v89, v93
 v_fmac_f32 v90, v92, v92
 v_fmac_f32 v91, v93, v93
v_lshlrev_b32 v92, 16, v124
 v_and_b32 v93, 0xffff0000, v124
v_add_f32 v88, v88, v92
 v_add_f32 v89, v89, v93
 v_fmac_f32 v90, v92, v92
 v_fmac_f32 v91, v93, v93
v_lshlrev_b32 v92, 16, v125
 v_and_b32 v93, 0xffff0000, v125
v_add_f32 v88, v88, v92
 v_add_f32 v89, v89, v93
 v_fmac_f32 v90, v92, v92
 v_fmac_f32 v91, v93, v93
v_lshlrev_b32 v92, 16, v126
 v_and_b32 v93, 0xffff0000, v126
v_add_f32 v88, v88, v92
 v_add_f32 v89, v89, v93
 v_fmac_f32 v90, v92, v92
 v_fmac_f32 v91, v93, v93
v_lshlrev_b32 v92, 16, v127
 v_and_b32 v93, 0xffff0000, v127
v_add_f32 v88, v88, v92
 v_add_f32 v89, v89, v93
 v_fmac_f32 v90, v92, v92
 v_fmac_f32 v91, v93, v93
v_lshlrev_b32 v92, 16, v128
 v_and_b32 v93, 0xffff0000, v128
v_add_f32 v88, v88, v92
 v_add_f32 v89, v89, v93
 v_fmac_f32 v90, v92, v92
 v_fmac_f32 v91, v93, v93
v_lshlrev_b32 v92, 16, v129
 v_and_b32 v93, 0xffff0000, v129
v_add_f32 v88, v88, v92
 v_add_f32 v89, v89, v93
 v_fmac_f32 v90, v92, v92
 v_fmac_f32 v91, v93, v93
v_lshlrev_b32 v92, 16, v130
 v_and_b32 v93, 0xffff0000, v130
v_add_f32 v88, v88, v92
 v_add_f32 v89, v89, v93
 v_fmac_f32 v90, v92, v92
 v_fmac_f32 v91, v93, v93
v_lshlrev_b32 v92, 16, v131
 v_and_b32 v93, 0xffff0000, v131
v_add_f32 v88, v88, v92
 v_add_f32 v89, v89, v93
 v_fmac_f32 v90, v92, v92
 v_fmac_f32 v91, v93, v93
v_lshlrev_b32 v92, 16, v132
 v_and_b32 v93, 0xffff0000, v132
v_add_f32 v88, v88, v92
 v_add_f32 v89, v89, v93
 v_fmac_f32 v90, v92, v92
 v_fmac_f32 v91, v93, v93
v_lshlrev_b32 v92, 16, v133
 v_and_b32 v93, 0xffff0000, v133
v_add_f32 v88, v88, v92
 v_add_f32 v89, v89, v93
 v_fmac_f32 v90, v92, v92
 v_fmac_f32 v91, v93, v93
v_lshlrev_b32 v92, 16, v134
 v_and_b32 v93, 0xffff0000, v134
v_add_f32 v88, v88, v92
 v_add_f32 v89, v89, v93
 v_fmac_f32 v90, v92, v92
 v_fmac_f32 v91, v93, v93
v_lshlrev_b32 v92, 16, v135
 v_and_b32 v93, 0xffff0000, v135
v_add_f32 v88, v88, v92
 v_add_f32 v89, v89, v93
 v_fmac_f32 v90, v92, v92
 v_fmac_f32 v91, v93, v93
v_add_f32 v88, v88, v89
 v_add_f32 v89, v90, v91
s_nop 0
v_add_f32_dpp v88, v88, v88 quad_perm:[1,0,3,2] row_mask:0xf bank_mask:0xf
v_add_f32_dpp v89, v89, v89 quad_perm:[1,0,3,2] row_mask:0xf bank_mask:0xf
s_nop 0
v_add_f32_dpp v88, v88, v88 quad_perm:[2,3,0,1] row_mask:0xf bank_mask:0xf
v_add_f32_dpp v89, v89, v89 quad_perm:[2,3,0,1] row_mask:0xf bank_mask:0xf
s_nop 0
v_add_f32_dpp v88, v88, v88 row_ror:8 row_mask:0xf bank_mask:0xf
v_add_f32_dpp v89, v89, v89 row_ror:8 row_mask:0xf bank_mask:0xf
v_mov_b32 v90, v88
v_mov_b32 v91, v89
s_nop 0
v_permlane16_swap_b32 v88, v90
v_permlane16_swap_b32 v89, v91
s_nop 0
v_add_f32 v88, v88, v90
v_add_f32 v89, v89, v91
v_mov_b32 v90, v88
v_mov_b32 v91, v89
s_nop 0
v_permlane32_swap_b32 v88, v90
v_permlane32_swap_b32 v89, v91
s_nop 0
v_add_f32 v88, v88, v90
v_add_f32 v89, v89, v91

    v_mul_f32 v88, 0x3a800000, v88
    v_mul_f32 v90, 0x3a800000, v89
    v_fma_f32 v90, -v88, v88, v90
    v_max_f32 v90, 0, v90
    v_add_f32 v90, 0x3727c5ac, v90
    v_rsq_f32 v89, v90

v_lshlrev_b32 v96, 16, v12
 v_and_b32 v97, 0xffff0000, v12
v_lshlrev_b32 v98, 16, v13
 v_and_b32 v99, 0xffff0000, v13
v_lshlrev_b32 v100, 16, v14
 v_and_b32 v101, 0xffff0000, v14
v_lshlrev_b32 v102, 16, v15
 v_and_b32 v103, 0xffff0000, v15
v_sub_f32 v96, v96, v88
v_sub_f32 v97, v97, v88
v_sub_f32 v98, v98, v88
v_sub_f32 v99, v99, v88
v_sub_f32 v100, v100, v88
v_sub_f32 v101, v101, v88
v_sub_f32 v102, v102, v88
v_sub_f32 v103, v103, v88
v_mul_f32 v96, v96, v89
v_mul_f32 v97, v97, v89
v_mul_f32 v98, v98, v89
v_mul_f32 v99, v99, v89
v_mul_f32 v100, v100, v89
v_mul_f32 v101, v101, v89
v_mul_f32 v102, v102, v89
v_mul_f32 v103, v103, v89
v_cvt_pk_bf16_f32 v16, v96, v97
v_cvt_pk_bf16_f32 v17, v98, v99
v_cvt_pk_bf16_f32 v18, v100, v101
v_cvt_pk_bf16_f32 v19, v102, v103
v_lshlrev_b32 v104, 16, v136
 v_and_b32 v105, 0xffff0000, v136
v_lshlrev_b32 v106, 16, v137
 v_and_b32 v107, 0xffff0000, v137
v_lshlrev_b32 v108, 16, v138
 v_and_b32 v109, 0xffff0000, v138
v_lshlrev_b32 v110, 16, v139
 v_and_b32 v111, 0xffff0000, v139
v_sub_f32 v104, v104, v88
v_sub_f32 v105, v105, v88
v_sub_f32 v106, v106, v88
v_sub_f32 v107, v107, v88
v_sub_f32 v108, v108, v88
v_sub_f32 v109, v109, v88
v_sub_f32 v110, v110, v88
v_sub_f32 v111, v111, v88
v_mul_f32 v104, v104, v89
v_mul_f32 v105, v105, v89
v_mul_f32 v106, v106, v89
v_mul_f32 v107, v107, v89
v_mul_f32 v108, v108, v89
v_mul_f32 v109, v109, v89
v_mul_f32 v110, v110, v89
v_mul_f32 v111, v111, v89
v_cvt_pk_bf16_f32 v140, v104, v105
v_cvt_pk_bf16_f32 v141, v106, v107
v_cvt_pk_bf16_f32 v142, v108, v109
v_cvt_pk_bf16_f32 v143, v110, v111
s_waitcnt vmcnt(8)
v_perm_b32 v88, v28, v24, s37
v_perm_b32 v89, v36, v32, s37
v_perm_b32 v90, v44, v40, s37
v_perm_b32 v91, v52, v48, s37
v_perm_b32 v92, v28, v24, s38
v_perm_b32 v93, v36, v32, s38
v_perm_b32 v94, v44, v40, s38
v_perm_b32 v95, v52, v48, s38
v_perm_b32 v96, v29, v25, s37
v_perm_b32 v97, v37, v33, s37
v_perm_b32 v98, v45, v41, s37
v_perm_b32 v99, v53, v49, s37
v_perm_b32 v100, v29, v25, s38
v_perm_b32 v101, v37, v33, s38
v_perm_b32 v102, v45, v41, s38
v_perm_b32 v103, v53, v49, s38
v_perm_b32 v104, v30, v26, s37
v_perm_b32 v105, v38, v34, s37
v_perm_b32 v106, v46, v42, s37
v_perm_b32 v107, v54, v50, s37
v_perm_b32 v108, v30, v26, s38
v_perm_b32 v109, v38, v34, s38
v_perm_b32 v110, v46, v42, s38
v_perm_b32 v111, v54, v50, s38
v_perm_b32 v112, v31, v27, s37
v_perm_b32 v113, v39, v35, s37
v_perm_b32 v114, v47, v43, s37
v_perm_b32 v115, v55, v51, s37
v_perm_b32 v116, v31, v27, s38
v_perm_b32 v117, v39, v35, s38
v_perm_b32 v118, v47, v43, s38
v_perm_b32 v119, v55, v51, s38
s_waitcnt vmcnt(0)
v_perm_b32 v24, v60, v56, s37
v_perm_b32 v25, v68, v64, s37
v_perm_b32 v26, v76, v72, s37
v_perm_b32 v27, v84, v80, s37
v_perm_b32 v28, v60, v56, s38
v_perm_b32 v29, v68, v64, s38
v_perm_b32 v30, v76, v72, s38
v_perm_b32 v31, v84, v80, s38
v_perm_b32 v32, v61, v57, s37
v_perm_b32 v33, v69, v65, s37
v_perm_b32 v34, v77, v73, s37
v_perm_b32 v35, v85, v81, s37
v_perm_b32 v36, v61, v57, s38
v_perm_b32 v37, v69, v65, s38
v_perm_b32 v38, v77, v73, s38
v_perm_b32 v39, v85, v81, s38
v_perm_b32 v40, v62, v58, s37
v_perm_b32 v41, v70, v66, s37
v_perm_b32 v42, v78, v74, s37
v_perm_b32 v43, v86, v82, s37
v_perm_b32 v44, v62, v58, s38
v_perm_b32 v45, v70, v66, s38
v_perm_b32 v46, v78, v74, s38
v_perm_b32 v47, v86, v82, s38
v_perm_b32 v48, v63, v59, s37
v_perm_b32 v49, v71, v67, s37
v_perm_b32 v50, v79, v75, s37
v_perm_b32 v51, v87, v83, s37
v_perm_b32 v52, v63, v59, s38
v_perm_b32 v53, v71, v67, s38
v_perm_b32 v54, v79, v75, s38
v_perm_b32 v55, v87, v83, s38
s_nop 1
v_mfma_f32_16x16x32_bf16 v[56:59], v[16:19], v[88:91], 0
v_mfma_f32_16x16x32_bf16 v[60:63], v[16:19], v[92:95], 0
v_mfma_f32_16x16x32_bf16 v[64:67], v[16:19], v[96:99], 0
v_mfma_f32_16x16x32_bf16 v[68:71], v[16:19], v[100:103], 0
v_mfma_f32_16x16x32_bf16 v[72:75], v[16:19], v[104:107], 0
v_mfma_f32_16x16x32_bf16 v[76:79], v[16:19], v[108:111], 0
v_mfma_f32_16x16x32_bf16 v[80:83], v[16:19], v[112:115], 0
v_mfma_f32_16x16x32_bf16 v[84:87], v[16:19], v[116:119], 0
v_mfma_f32_16x16x32_bf16 v[56:59], v[140:143], v[24:27], v[56:59]
v_mfma_f32_16x16x32_bf16 v[60:63], v[140:143], v[28:31], v[60:63]
v_mfma_f32_16x16x32_bf16 v[64:67], v[140:143], v[32:35], v[64:67]
v_mfma_f32_16x16x32_bf16 v[68:71], v[140:143], v[36:39], v[68:71]
v_mfma_f32_16x16x32_bf16 v[72:75], v[140:143], v[40:43], v[72:75]
v_mfma_f32_16x16x32_bf16 v[76:79], v[140:143], v[44:47], v[76:79]
v_mfma_f32_16x16x32_bf16 v[80:83], v[140:143], v[48:51], v[80:83]
v_mfma_f32_16x16x32_bf16 v[84:87], v[140:143], v[52:55], v[84:87]
s_nop 7
v_cndmask_b32 v20, v56, v72, s[40:41]
v_cndmask_b32 v21, v60, v76, s[40:41]
v_cndmask_b32 v22, v64, v80, s[40:41]
v_cndmask_b32 v23, v68, v84, s[40:41]
v_perm_b32 v20, v20, v6, s33
v_perm_b32 v21, v21, v6, s34
v_perm_b32 v22, v22, v6, s35
v_perm_b32 v23, v23, v6, s36

    ds_write_b128 v7, v[20:23] offset:2816
    s_cmp_lg_u32 s27, 0
    s_cbranch_scc1 L_q_nored
    v_lshlrev_b32 v7, 4, v0

s_mov_b32 s60, 0
L_redq_1:
s_cbranch_execz L_grd_3
ds_read_b128 v[120:123], v7 offset:2816
ds_read_b128 v[124:127], v7 offset:3840
ds_read_b128 v[128:131], v7 offset:4864
ds_read_b128 v[132:135], v7 offset:5888
L_grd_3:
s_cbranch_execz L_grd_4
s_waitcnt lgkmcnt(0)
L_grd_4:
v_xor_b32 v20, s29, v120
v_xor_b32 v21, s30, v121
v_xor_b32 v22, s31, v122
v_xor_b32 v23, s32, v123
v_bitop3_b32 v20, v124, s29, v20 bitop3:0xbe
v_bitop3_b32 v21, v125, s30, v21 bitop3:0xbe
v_bitop3_b32 v22, v126, s31, v22 bitop3:0xbe
v_bitop3_b32 v23, v127, s32, v23 bitop3:0xbe
v_bitop3_b32 v20, v128, s29, v20 bitop3:0xbe
v_bitop3_b32 v21, v129, s30, v21 bitop3:0xbe
v_bitop3_b32 v22, v130, s31, v22 bitop3:0xbe
v_bitop3_b32 v23, v131, s32, v23 bitop3:0xbe
v_bitop3_b32 v20, v132, s29, v20 bitop3:0xbe
v_bitop3_b32 v21, v133, s30, v21 bitop3:0xbe
v_bitop3_b32 v22, v134, s31, v22 bitop3:0xbe
v_bitop3_b32 v23, v135, s32, v23 bitop3:0xbe
v_or3_b32 v20, v20, v21, v22
v_or_b32 v20, v20, v23
v_and_b32 v20, 0xff, v20
v_cmp_ne_u32 vcc, 0, v20
s_nop 0
s_cbranch_vccz L_redqok_2
s_add_u32 s60, s60, 1
s_cmp_lt_u32 s60, 4000
s_cbranch_scc1 L_redq_1
s_branch L_abort
L_redqok_2:
v_pk_add_f32 v[120:121], v[120:121], v[124:125]
 v_pk_add_f32 v[128:129], v[128:129], v[132:133]
v_pk_add_f32 v[122:123], v[122:123], v[126:127]
 v_pk_add_f32 v[130:131], v[130:131], v[134:135]
v_pk_add_f32 v[120:121], v[120:121], v[128:129]
v_pk_add_f32 v[122:123], v[122:123], v[130:131]
v_perm_b32 v20, v120, v6, s33
v_perm_b32 v21, v121, v6, s34
v_perm_b32 v22, v122, v6, s35
v_perm_b32 v23, v123, v6, s36

    s_lshl_b32 s61, s53, 13
    s_lshl_b32 s62, s52, 8
    s_add_u32 s61, s61, s62
    s_add_u32 s61, s61, 65536
    v_and_b32 v7, 1, v2
    v_lshl_add_u32 v7, v7, 12, v10
    v_add_u32 v7, s61, v7
    global_store_dwordx4 v7, v[20:23], s[24:25] sc1

L_q_nored:

    s_and_b32 s61, s2, 7
    s_lshr_b32 s46, s61, 2
    s_and_b32 s47, s61, 3
    s_lshr_b32 s54, s61, 1
    s_lshr_b32 s55, s2, 3
    s_lshl_b32 s58, s54, 3
    s_and_b32 s61, s55, 7
    s_add_u32 s58, s58, s61
    s_and_b32 s61, s55, 1
    s_lshl_b32 s57, s54, 1
    s_add_u32 s57, s57, s61
    s_lshr_b32 s59, s55, 1
    s_lshr_b32 s61, s55, 2
    s_mul_i32 s53, s54, 7
    s_add_u32 s53, s53, s61
    s_lshl_b32 s61, s57, 8
    s_lshl_b32 s62, s27, 6
    s_add_u32 s61, s61, s62
    v_lshlrev_b32 v9, 3, v2
    v_lshl_add_u32 v9, v4, 11, v9
    v_add_u32 v9, s61, v9
    v_and_b32 v7, 1, v3
    v_lshl_add_u32 v9, v7, 2, v9
    v_bfe_u32 v7, v3, 1, 1
    v_lshl_add_u32 v9, v7, 5, v9
    global_load_dword v12, v9, s[4:5]
    v_and_b32 v1, 31, v0
    v_lshlrev_b32 v1, 4, v1
    v_lshrrev_b32 v7, 5, v0
    v_mul_u32_u24 v7, 544, v7
    v_add_u32 v11, v7, v1
    v_and_b32 v7, 3, v3
    v_mul_u32_u24 v7, 1088, v7
    v_mul_u32_u24 v8, 544, v4
    v_add_u32 v7, v7, v8
    v_lshl_add_u32 v5, v2, 4, v7
    v_mul_u32_u24 v8, 544, v4
    v_lshl_add_u32 v5, v2, 4, v8
    v_and_b32 v8, 1, v3
    v_lshl_add_u32 v5, v8, 3, v5
    v_bfe_u32 v8, v3, 1, 1
    v_lshl_add_u32 v5, v8, 6, v5
    s_mul_i32 s61, s27, 1088
    v_add_u32 v11, s61, v11
    s_lshl_b32 s61, s27, 7
    v_add_u32 v5, s61, v5

        s_mov_b64 s[14:15], 0
        s_mov_b64 exec, 0
        s_branch L_tail
        L_dry_done:
        s_mov_b64 s[14:15], -1
        s_mov_b64 exec, -1
        s_setprio 3

    s_and_b32 s61, s2, 3
    s_lshl_b32 s61, s61, 3
    s_lshl_b32 s62, s27, 1
    s_add_u32 s61, s61, s62
    s_lshl_b32 s61, s61, 1
    s_bfe_u32 s62, s2, 0x10002
    s_add_u32 s61, s61, s62
    s_lshl_b32 s61, s61, 12
    s_add_u32 s61, s61, 65536
    s_add_u32 s10, s24, s61
    s_addc_u32 s11, s25, 0
    s_add_u32 s46, s10, 8192
    s_addc_u32 s47, s11, 0
    v_lshlrev_b32 v9, 4, v0

s_mov_b32 s60, 0
L_qg_5:
s_cbranch_execz L_grd_7
global_load_dwordx4 v[56:59], v9, s[10:11] offset:0 sc1
global_load_dwordx4 v[60:63], v9, s[10:11] offset:1024 sc1
global_load_dwordx4 v[72:75], v9, s[46:47] offset:0 sc1
global_load_dwordx4 v[76:79], v9, s[46:47] offset:1024 sc1
L_grd_7:
s_cbranch_execz L_grd_8
s_waitcnt vmcnt(0)
L_grd_8:
v_xor_b32 v20, s29, v56
v_xor_b32 v21, s30, v57
v_xor_b32 v22, s31, v58
v_xor_b32 v23, s32, v59
v_bitop3_b32 v20, v60, s29, v20 bitop3:0xbe
v_bitop3_b32 v21, v61, s30, v21 bitop3:0xbe
v_bitop3_b32 v22, v62, s31, v22 bitop3:0xbe
v_bitop3_b32 v23, v63, s32, v23 bitop3:0xbe
v_bitop3_b32 v20, v72, s29, v20 bitop3:0xbe
v_bitop3_b32 v21, v73, s30, v21 bitop3:0xbe
v_bitop3_b32 v22, v74, s31, v22 bitop3:0xbe
v_bitop3_b32 v23, v75, s32, v23 bitop3:0xbe
v_bitop3_b32 v20, v76, s29, v20 bitop3:0xbe
v_bitop3_b32 v21, v77, s30, v21 bitop3:0xbe
v_bitop3_b32 v22, v78, s31, v22 bitop3:0xbe
v_bitop3_b32 v23, v79, s32, v23 bitop3:0xbe
v_or3_b32 v20, v20, v21, v22
v_or_b32 v20, v20, v23
v_and_b32 v20, 0xff, v20
v_cmp_ne_u32 vcc, 0, v20
s_nop 0
s_cbranch_vccz L_qgok_6
s_add_u32 s60, s60, 1
s_sleep 4
s_cmp_lt_u32 s60, 4000
s_cbranch_scc1 L_qg_5
s_branch L_abort
L_qgok_6:
v_add_f32 v56, v56, v60
v_add_f32 v57, v57, v61
v_add_f32 v58, v58, v62
v_add_f32 v59, v59, v63
v_add_f32 v72, v72, v76
v_add_f32 v73, v73, v77
v_add_f32 v74, v74, v78
v_add_f32 v75, v75, v79
s_nop 1
v_permlane32_swap_b32 v56, v72
v_permlane32_swap_b32 v57, v73
v_permlane32_swap_b32 v58, v74
v_permlane32_swap_b32 v59, v75
s_nop 1
v_add_f32 v56, v56, v72
v_add_f32 v57, v57, v73
v_add_f32 v58, v58, v74
v_add_f32 v59, v59, v75

    v_cvt_pk_bf16_f32 v60, v56, v57
    v_cvt_pk_bf16_f32 v61, v58, v59
    v_lshrrev_b32 v7, 5, v0
    s_lshl_b32 s61, s27, 1
    v_add_u32 v7, s61, v7
    v_mul_u32_u24 v7, 272, v7
    v_and_b32 v8, 31, v0
    v_lshl_add_u32 v7, v8, 3, v7
    ds_write_b64 v7, v[60:61] offset:0
    v_mov_b32 v8, 0
    v_mov_b32 v9, 1
    s_waitcnt lgkmcnt(0)
    s_mov_b64 exec, 1
    ds_add_u32 v8, v9 offset:6912
    s_mov_b64 exec, -1

s_setprio 1
L_tail:

    s_bitcmp1_b32 s2, 0
    s_cbranch_scc0 L_Y

v_mov_b32 v8, 0

        s_mov_b32 s60, 0
        s_cbranch_execz L_vwok_10
        L_vw_9:
        ds_read_b32 v9, v8 offset:6916
        s_waitcnt lgkmcnt(0)
        v_readfirstlane_b32 s61, v9
        s_cmp_ge_u32 s61, 8
        s_cbranch_scc1 L_vwok_10
        s_add_u32 s60, s60, 1
s_sleep 2

        s_cmp_lt_u32 s60, 400000
        s_cbranch_scc1 L_vw_9
        s_branch L_abort
        L_vwok_10:
s_setprio 0

            s_lshl_b32 s61, s58, 7
            s_lshl_b32 s62, s27, 5
            s_add_u32 s61, s61, s62
            s_lshl_b32 s61, s61, 11
            s_lshr_b32 s62, s55, 3
            s_lshl_b32 s62, s62, 9
            s_add_u32 s61, s61, s62

        s_add_u32 s44, s12, s61
        s_addc_u32 s45, s13, 0
        s_add_u32 s6, s44, 256
        s_addc_u32 s7, s45, 0
        v_lshlrev_b32 v8, 12, v2
        v_lshl_add_u32 v8, v3, 4, v8
s_cbranch_execz L_grd_11
global_load_dwordx4 v[24:27], v8, s[44:45] nt
s_add_u32 s44, s44, 16384
 s_addc_u32 s45, s45, 0
global_load_dwordx4 v[28:31], v8, s[44:45] nt
s_add_u32 s44, s44, 16384
 s_addc_u32 s45, s45, 0
global_load_dwordx4 v[32:35], v8, s[44:45] nt
s_add_u32 s44, s44, 16384
 s_addc_u32 s45, s45, 0
global_load_dwordx4 v[36:39], v8, s[44:45] nt
s_sub_u32 s44, s44, 47104
 s_subb_u32 s45, s45, 0
global_load_dwordx4 v[40:43], v8, s[44:45] nt
s_add_u32 s44, s44, 16384
 s_addc_u32 s45, s45, 0
global_load_dwordx4 v[44:47], v8, s[44:45] nt
s_add_u32 s44, s44, 16384
 s_addc_u32 s45, s45, 0
global_load_dwordx4 v[48:51], v8, s[44:45] nt
s_add_u32 s44, s44, 16384
 s_addc_u32 s45, s45, 0
global_load_dwordx4 v[52:55], v8, s[44:45] nt
global_load_dwordx4 v[56:59], v8, s[6:7] nt
s_add_u32 s6, s6, 16384
 s_addc_u32 s7, s7, 0
global_load_dwordx4 v[60:63], v8, s[6:7] nt
s_add_u32 s6, s6, 16384
 s_addc_u32 s7, s7, 0
global_load_dwordx4 v[64:67], v8, s[6:7] nt
s_add_u32 s6, s6, 16384
 s_addc_u32 s7, s7, 0
global_load_dwordx4 v[68:71], v8, s[6:7] nt
s_sub_u32 s6, s6, 47104
 s_subb_u32 s7, s7, 0
global_load_dwordx4 v[72:75], v8, s[6:7] nt
s_add_u32 s6, s6, 16384
 s_addc_u32 s7, s7, 0
global_load_dwordx4 v[76:79], v8, s[6:7] nt
s_add_u32 s6, s6, 16384
 s_addc_u32 s7, s7, 0
global_load_dwordx4 v[80:83], v8, s[6:7] nt
s_add_u32 s6, s6, 16384
 s_addc_u32 s7, s7, 0
global_load_dwordx4 v[84:87], v8, s[6:7] nt
L_grd_11:
s_setprio 1
s_cbranch_execz L_grd_12
s_barrier
 s_barrier
L_grd_12:

    s_lshl_b32 s61, s58, 9
    s_add_u32 s61, s61, 524288
    v_lshrrev_b32 v8, 5, v0
    v_lshl_add_u32 v167, v8, 14, v1
    v_add_u32 v167, s61, v167

        s_lshl_b32 s62, s58, 14
        s_lshl_b32 s61, s27, 12
        s_add_u32 s62, s62, s61
        s_add_u32 s62, s62, 1048576
        s_add_u32 s10, s24, s62
        s_addc_u32 s11, s25, 0
        v_lshrrev_b32 v8, 5, v0
        v_lshl_add_u32 v9, v8, 19, v1

            v_bfe_u32 v8, v0, 3, 1
            v_and_b32 v7, 7, v0
            v_lshlrev_b32 v7, 9, v7
            v_lshl_add_u32 v7, v8, 19, v7

s_and_b32 exec_lo, s14, 0xffff
 s_and_b32 exec_hi, s15, 0
s_mov_b32 s60, 0
s_cbranch_execz L_grd_18
global_load_dwordx4 v[16:19], v7, s[10:11] sc1
global_load_dwordx4 v[156:159], v7, s[10:11] sc1
L_grd_18:
L_hO_13:
s_cbranch_execz L_grd_19
global_load_dwordx4 v[160:163], v7, s[10:11] sc1
s_waitcnt vmcnt(2)
L_grd_19:
v_xor_b32 v20, s29, v16
v_xor_b32 v21, s30, v17
v_xor_b32 v22, s31, v18
v_xor_b32 v23, s32, v19
v_or3_b32 v20, v20, v21, v22
v_or_b32 v20, v20, v23
v_and_b32 v20, 0xff, v20
v_cmp_ne_u32 vcc, 0, v20
s_nop 0
s_cbranch_vccz L_hOk0_15
s_sleep 1
s_cbranch_execz L_grd_20
global_load_dwordx4 v[16:19], v7, s[10:11] sc1
s_waitcnt vmcnt(2)
L_grd_20:
v_xor_b32 v20, s29, v156
v_xor_b32 v21, s30, v157
v_xor_b32 v22, s31, v158
v_xor_b32 v23, s32, v159
v_or3_b32 v20, v20, v21, v22
v_or_b32 v20, v20, v23
v_and_b32 v20, 0xff, v20
v_cmp_ne_u32 vcc, 0, v20
s_nop 0
s_cbranch_vccz L_hOk1_16
s_sleep 1
s_cbranch_execz L_grd_21
global_load_dwordx4 v[156:159], v7, s[10:11] sc1
s_waitcnt vmcnt(2)
L_grd_21:
v_xor_b32 v20, s29, v160
v_xor_b32 v21, s30, v161
v_xor_b32 v22, s31, v162
v_xor_b32 v23, s32, v163
v_or3_b32 v20, v20, v21, v22
v_or_b32 v20, v20, v23
v_and_b32 v20, 0xff, v20
v_cmp_ne_u32 vcc, 0, v20
s_nop 0
s_cbranch_vccz L_hOk2_17
s_sleep 1
s_add_u32 s60, s60, 1
s_cmp_lt_u32 s60, 4000
s_cbranch_scc1 L_hO_13
s_branch L_abort
L_hOk0_15:
s_branch L_hOok_14
L_hOk1_16:
s_branch L_hOok_14
L_hOk2_17:
L_hOok_14:
s_mov_b64 exec, s[14:15]
s_mov_b32 s60, 0
s_cbranch_execz L_grd_24
v_mov_b32 v8, v167
global_load_dwordx4 v[152:155], v8, s[24:25] sc1
global_load_dwordx4 v[120:123], v9, s[10:11] offset:0 sc1
global_load_dwordx4 v[124:127], v9, s[10:11] offset:512 sc1
global_load_dwordx4 v[128:131], v9, s[10:11] offset:1024 sc1
global_load_dwordx4 v[132:135], v9, s[10:11] offset:1536 sc1
global_load_dwordx4 v[136:139], v9, s[10:11] offset:2048 sc1
global_load_dwordx4 v[140:143], v9, s[10:11] offset:2560 sc1
global_load_dwordx4 v[144:147], v9, s[10:11] offset:3072 sc1
global_load_dwordx4 v[148:151], v9, s[10:11] offset:3584 sc1
L_grd_24:
v_perm_b32 v88, v28, v24, s37
v_perm_b32 v89, v36, v32, s37
v_perm_b32 v90, v44, v40, s37
v_perm_b32 v91, v52, v48, s37
v_perm_b32 v92, v28, v24, s38
v_perm_b32 v93, v36, v32, s38
v_perm_b32 v94, v44, v40, s38
v_perm_b32 v95, v52, v48, s38
v_perm_b32 v96, v29, v25, s37
v_perm_b32 v97, v37, v33, s37
v_perm_b32 v98, v45, v41, s37
v_perm_b32 v99, v53, v49, s37
v_perm_b32 v100, v29, v25, s38
v_perm_b32 v101, v37, v33, s38
v_perm_b32 v102, v45, v41, s38
v_perm_b32 v103, v53, v49, s38
v_perm_b32 v104, v30, v26, s37
v_perm_b32 v105, v38, v34, s37
v_perm_b32 v106, v46, v42, s37
v_perm_b32 v107, v54, v50, s37
v_perm_b32 v108, v30, v26, s38
v_perm_b32 v109, v38, v34, s38
v_perm_b32 v110, v46, v42, s38
v_perm_b32 v111, v54, v50, s38
v_perm_b32 v112, v31, v27, s37
v_perm_b32 v113, v39, v35, s37
v_perm_b32 v114, v47, v43, s37
v_perm_b32 v115, v55, v51, s37
v_perm_b32 v116, v31, v27, s38
v_perm_b32 v117, v39, v35, s38
v_perm_b32 v118, v47, v43, s38
v_perm_b32 v119, v55, v51, s38
v_perm_b32 v24, v60, v56, s37
v_perm_b32 v25, v68, v64, s37
v_perm_b32 v26, v76, v72, s37
v_perm_b32 v27, v84, v80, s37
v_perm_b32 v28, v60, v56, s38
v_perm_b32 v29, v68, v64, s38
v_perm_b32 v30, v76, v72, s38
v_perm_b32 v31, v84, v80, s38
v_perm_b32 v32, v61, v57, s37
v_perm_b32 v33, v69, v65, s37
v_perm_b32 v34, v77, v73, s37
v_perm_b32 v35, v85, v81, s37
v_perm_b32 v36, v61, v57, s38
v_perm_b32 v37, v69, v65, s38
v_perm_b32 v38, v77, v73, s38
v_perm_b32 v39, v85, v81, s38
v_perm_b32 v40, v62, v58, s37
v_perm_b32 v41, v70, v66, s37
v_perm_b32 v42, v78, v74, s37
v_perm_b32 v43, v86, v82, s37
v_perm_b32 v44, v62, v58, s38
v_perm_b32 v45, v70, v66, s38
v_perm_b32 v46, v78, v74, s38
v_perm_b32 v47, v86, v82, s38
v_perm_b32 v48, v63, v59, s37
v_perm_b32 v49, v71, v67, s37
v_perm_b32 v50, v79, v75, s37
v_perm_b32 v51, v87, v83, s37
v_perm_b32 v52, v63, v59, s38
v_perm_b32 v53, v71, v67, s38
v_perm_b32 v54, v79, v75, s38
v_perm_b32 v55, v87, v83, s38
L_swA_22:
s_cbranch_execz L_grd_25
s_waitcnt vmcnt(8)
L_grd_25:
v_xor_b32 v20, s29, v152
v_xor_b32 v21, s30, v153
v_xor_b32 v22, s31, v154
v_xor_b32 v23, s32, v155
v_or3_b32 v159, v20, v21, v22
v_or_b32 v159, v159, v23
v_mov_b32 v164, v152
s_nop 1
v_max_f32_dpp v164, v164, v164 quad_perm:[1,0,3,2] row_mask:0xf bank_mask:0xf
s_nop 1
v_max_f32_dpp v164, v164, v164 quad_perm:[2,3,0,1] row_mask:0xf bank_mask:0xf
s_nop 1
v_max_f32_dpp v164, v164, v164 row_ror:4 row_mask:0xf bank_mask:0xf
s_nop 1
v_max_f32_dpp v164, v164, v164 row_ror:8 row_mask:0xf bank_mask:0xf
v_mov_b32 v166, v164
s_nop 1
v_permlane16_swap_b32 v164, v166
s_nop 1
v_max_f32 v164, v164, v166

        v_sub_f32 v164, v152, v164
        v_exp_f32 v164, v164
        s_nop 0
        v_mul_f32 v165, v164, v153
s_nop 1
v_add_f32_dpp v165, v165, v165 quad_perm:[1,0,3,2] row_mask:0xf bank_mask:0xf
s_nop 1
v_add_f32_dpp v165, v165, v165 quad_perm:[2,3,0,1] row_mask:0xf bank_mask:0xf
s_nop 1
v_add_f32_dpp v165, v165, v165 row_ror:4 row_mask:0xf bank_mask:0xf
s_nop 1
v_add_f32_dpp v165, v165, v165 row_ror:8 row_mask:0xf bank_mask:0xf
v_mov_b32 v166, v165
s_nop 1
v_permlane16_swap_b32 v165, v166
s_nop 1
v_add_f32 v165, v165, v166

        v_rcp_f32 v165, v165
        s_nop 0
        v_mul_f32 v164, v164, v165
        s_lshl_b32 s61, s27, 8
        v_lshl_add_u32 v7, v0, 2, s61
        ds_write_b32 v7, v164 offset:16896
        v_lshrrev_b32 v8, 5, v0
        s_lshl_b32 s62, s27, 5
        s_add_u32 s61, s61, s62
        v_lshl_add_u32 v7, v8, 7, s61
        ds_read_b128 v[16:19], v7 offset:16896
        ds_read_b128 v[160:163], v7 offset:16912

s_cbranch_execz L_grd_26
s_waitcnt vmcnt(0)
L_grd_26:
v_xor_b32 v20, s29, v120
v_xor_b32 v21, s30, v121
v_xor_b32 v22, s31, v122
v_xor_b32 v23, s32, v123
v_bitop3_b32 v20, v124, s29, v20 bitop3:0xbe
v_bitop3_b32 v21, v125, s30, v21 bitop3:0xbe
v_bitop3_b32 v22, v126, s31, v22 bitop3:0xbe
v_bitop3_b32 v23, v127, s32, v23 bitop3:0xbe
v_bitop3_b32 v20, v128, s29, v20 bitop3:0xbe
v_bitop3_b32 v21, v129, s30, v21 bitop3:0xbe
v_bitop3_b32 v22, v130, s31, v22 bitop3:0xbe
v_bitop3_b32 v23, v131, s32, v23 bitop3:0xbe
v_bitop3_b32 v20, v132, s29, v20 bitop3:0xbe
v_bitop3_b32 v21, v133, s30, v21 bitop3:0xbe
v_bitop3_b32 v22, v134, s31, v22 bitop3:0xbe
v_bitop3_b32 v23, v135, s32, v23 bitop3:0xbe
v_bitop3_b32 v20, v136, s29, v20 bitop3:0xbe
v_bitop3_b32 v21, v137, s30, v21 bitop3:0xbe
v_bitop3_b32 v22, v138, s31, v22 bitop3:0xbe
v_bitop3_b32 v23, v139, s32, v23 bitop3:0xbe
v_bitop3_b32 v20, v140, s29, v20 bitop3:0xbe
v_bitop3_b32 v21, v141, s30, v21 bitop3:0xbe
v_bitop3_b32 v22, v142, s31, v22 bitop3:0xbe
v_bitop3_b32 v23, v143, s32, v23 bitop3:0xbe
v_bitop3_b32 v20, v144, s29, v20 bitop3:0xbe
v_bitop3_b32 v21, v145, s30, v21 bitop3:0xbe
v_bitop3_b32 v22, v146, s31, v22 bitop3:0xbe
v_bitop3_b32 v23, v147, s32, v23 bitop3:0xbe
v_bitop3_b32 v20, v148, s29, v20 bitop3:0xbe
v_bitop3_b32 v21, v149, s30, v21 bitop3:0xbe
v_bitop3_b32 v22, v150, s31, v22 bitop3:0xbe
v_bitop3_b32 v23, v151, s32, v23 bitop3:0xbe
v_or3_b32 v20, v20, v21, v22
 v_or3_b32 v20, v20, v23, v159
 v_and_b32 v20, 0xff, v20
 v_cmp_ne_u32 vcc, 0, v20
s_nop 0
 s_cbranch_vccz L_swAok_23
s_add_u32 s60, s60, 1
 s_sleep 1
 s_waitcnt lgkmcnt(0)
s_cbranch_execz L_grd_27
v_mov_b32 v8, v167
global_load_dwordx4 v[152:155], v8, s[24:25] sc1
global_load_dwordx4 v[120:123], v9, s[10:11] offset:0 sc1
global_load_dwordx4 v[124:127], v9, s[10:11] offset:512 sc1
global_load_dwordx4 v[128:131], v9, s[10:11] offset:1024 sc1
global_load_dwordx4 v[132:135], v9, s[10:11] offset:1536 sc1
global_load_dwordx4 v[136:139], v9, s[10:11] offset:2048 sc1
global_load_dwordx4 v[140:143], v9, s[10:11] offset:2560 sc1
global_load_dwordx4 v[144:147], v9, s[10:11] offset:3072 sc1
global_load_dwordx4 v[148:151], v9, s[10:11] offset:3584 sc1
L_grd_27:
s_cmp_lt_u32 s60, 4000
 s_cbranch_scc1 L_swA_22
 s_branch L_abort
L_swAok_23:
s_waitcnt lgkmcnt(0)
v_mul_f32 v120, v120, v16
v_mul_f32 v121, v121, v16
v_mul_f32 v122, v122, v16
v_mul_f32 v123, v123, v16
v_fmac_f32 v120, v124, v17
v_fmac_f32 v121, v125, v17
v_fmac_f32 v122, v126, v17
v_fmac_f32 v123, v127, v17
v_fmac_f32 v120, v128, v18
v_fmac_f32 v121, v129, v18
v_fmac_f32 v122, v130, v18
v_fmac_f32 v123, v131, v18
v_fmac_f32 v120, v132, v19
v_fmac_f32 v121, v133, v19
v_fmac_f32 v122, v134, v19
v_fmac_f32 v123, v135, v19
v_fmac_f32 v120, v136, v160
v_fmac_f32 v121, v137, v160
v_fmac_f32 v122, v138, v160
v_fmac_f32 v123, v139, v160
v_fmac_f32 v120, v140, v161
v_fmac_f32 v121, v141, v161
v_fmac_f32 v122, v142, v161
v_fmac_f32 v123, v143, v161
v_fmac_f32 v120, v144, v162
v_fmac_f32 v121, v145, v162
v_fmac_f32 v122, v146, v162
v_fmac_f32 v123, v147, v162
v_fmac_f32 v120, v148, v163
v_fmac_f32 v121, v149, v163
v_fmac_f32 v122, v150, v163
v_fmac_f32 v123, v151, v163
ds_write_b128 v11, v[120:123] offset:12544
s_waitcnt lgkmcnt(0)
s_cbranch_execz L_grd_28
s_barrier
L_grd_28:
ds_read_b64 v[140:141], v5 offset:12544
ds_read_b64 v[142:143], v5 offset:13632
ds_read_b64 v[144:145], v5 offset:14720
ds_read_b64 v[146:147], v5 offset:15808

        s_waitcnt lgkmcnt(2)
        v_pk_add_f32 v[140:141], v[140:141], v[142:143]
        s_waitcnt lgkmcnt(0)
        v_pk_add_f32 v[144:145], v[144:145], v[146:147]
        v_pk_add_f32 v[140:141], v[140:141], v[144:145]
v_cvt_pk_bf16_f32 v144, v140, v141
 s_nop 1
v_mov_b32_dpp v16, v144 quad_perm:[0,0,0,0] row_mask:0xf bank_mask:0xf
v_mov_b32_dpp v17, v144 quad_perm:[1,1,1,1] row_mask:0xf bank_mask:0xf
v_mov_b32_dpp v18, v144 quad_perm:[2,2,2,2] row_mask:0xf bank_mask:0xf
v_mov_b32_dpp v19, v144 quad_perm:[3,3,3,3] row_mask:0xf bank_mask:0xf
s_nop 1
v_mfma_f32_16x16x32_bf16 v[120:123], v[16:19], v[88:91], 0
v_mfma_f32_16x16x32_bf16 v[124:127], v[16:19], v[92:95], 0
v_mfma_f32_16x16x32_bf16 v[128:131], v[16:19], v[96:99], 0
v_mfma_f32_16x16x32_bf16 v[132:135], v[16:19], v[100:103], 0
v_mfma_f32_16x16x32_bf16 v[136:139], v[16:19], v[104:107], 0
v_mfma_f32_16x16x32_bf16 v[140:143], v[16:19], v[108:111], 0
v_mfma_f32_16x16x32_bf16 v[144:147], v[16:19], v[112:115], 0
v_mfma_f32_16x16x32_bf16 v[148:151], v[16:19], v[116:119], 0
v_mfma_f32_16x16x32_bf16 v[56:59], v[16:19], v[24:27], 0
v_mfma_f32_16x16x32_bf16 v[60:63], v[16:19], v[28:31], 0
v_mfma_f32_16x16x32_bf16 v[64:67], v[16:19], v[32:35], 0
v_mfma_f32_16x16x32_bf16 v[68:71], v[16:19], v[36:39], 0
v_mfma_f32_16x16x32_bf16 v[72:75], v[16:19], v[40:43], 0
v_mfma_f32_16x16x32_bf16 v[76:79], v[16:19], v[44:47], 0
v_mfma_f32_16x16x32_bf16 v[80:83], v[16:19], v[48:51], 0
v_mfma_f32_16x16x32_bf16 v[84:87], v[16:19], v[52:55], 0
s_lshl_b32 s61, s27, 10
 v_lshl_add_u32 v7, v0, 4, s61
v_cndmask_b32 v20, v120, v136, s[40:41]
v_cndmask_b32 v21, v124, v140, s[40:41]
v_cndmask_b32 v22, v128, v144, s[40:41]
v_cndmask_b32 v23, v132, v148, s[40:41]
ds_write_b128 v7, v[20:23] offset:28928
v_cndmask_b32 v16, v56, v72, s[40:41]
v_cndmask_b32 v17, v60, v76, s[40:41]
v_cndmask_b32 v18, v64, v80, s[40:41]
v_cndmask_b32 v19, v68, v84, s[40:41]
ds_write_b128 v7, v[16:19] offset:33024
s_waitcnt lgkmcnt(0)
s_cbranch_execz L_grd_30
s_barrier
L_grd_30:

        s_cmp_ge_u32 s27, 2
        s_cbranch_scc1 L_noreda_29
        s_mul_i32 s61, s27, 4096
        v_lshl_add_u32 v7, v0, 4, s61
ds_read_b128 v[152:155], v7 offset:28928
ds_read_b128 v[156:159], v7 offset:29952
ds_read_b128 v[160:163], v7 offset:30976
ds_read_b128 v[164:167], v7 offset:32000

        s_lshr_b32 s61, s55, 3
        s_lshl_b32 s61, s61, 1
        s_add_u32 s61, s61, s27
        s_lshl_b32 s61, s61, 6
        s_add_u32 s61, s61, s58
        s_lshl_b32 s61, s61, 9
        s_add_u32 s61, s61, 2097152
        v_and_b32 v7, 1, v2
        v_lshl_add_u32 v7, v7, 14, v10
        v_add_u32 v7, s61, v7
s_waitcnt lgkmcnt(0)
v_pk_add_f32 v[152:153], v[152:153], v[156:157]
 v_pk_add_f32 v[160:161], v[160:161], v[164:165]
v_pk_add_f32 v[154:155], v[154:155], v[158:159]
 v_pk_add_f32 v[162:163], v[162:163], v[166:167]
v_pk_add_f32 v[152:153], v[152:153], v[160:161]
v_pk_add_f32 v[154:155], v[154:155], v[162:163]
v_perm_b32 v20, v152, v6, s33
v_perm_b32 v21, v153, v6, s34
v_perm_b32 v22, v154, v6, s35
v_perm_b32 v23, v155, v6, s36
s_cbranch_execz L_grd_31
global_store_dwordx4 v7, v[20:23], s[24:25] sc1
L_grd_31:
L_noreda_29:
s_waitcnt lgkmcnt(0)
s_cbranch_execz L_grd_32
s_barrier
L_grd_32:

    s_cmp_ge_u32 s55, 28
    s_cbranch_scc1 L_skipC1

            s_lshl_b32 s61, s53, 7
            s_lshl_b32 s62, s27, 5
            s_add_u32 s61, s61, s62
            s_lshl_b32 s61, s61, 11
            s_and_b32 s62, s55, 3
            s_lshl_b32 s62, s62, 9
            s_add_u32 s61, s61, s62

        s_add_u32 s44, s18, s61
        s_addc_u32 s45, s19, 0
        s_add_u32 s6, s44, 256
        s_addc_u32 s7, s45, 0

            v_lshlrev_b32 v8, 13, v2
            v_lshl_add_u32 v8, v3, 4, v8
s_cbranch_execz L_grd_33
global_load_dwordx4 v[88:91], v8, s[44:45] nt
s_add_u32 s44, s44, 2048
 s_addc_u32 s45, s45, 0
global_load_dwordx4 v[92:95], v8, s[44:45] nt
s_add_u32 s44, s44, 2048
 s_addc_u32 s45, s45, 0
global_load_dwordx4 v[96:99], v8, s[44:45] nt
s_add_u32 s44, s44, 2048
 s_addc_u32 s45, s45, 0
global_load_dwordx4 v[100:103], v8, s[44:45] nt
s_add_u32 s44, s44, 26624
 s_addc_u32 s45, s45, 0
global_load_dwordx4 v[104:107], v8, s[44:45] nt
s_add_u32 s44, s44, 2048
 s_addc_u32 s45, s45, 0
global_load_dwordx4 v[108:111], v8, s[44:45] nt
s_add_u32 s44, s44, 2048
 s_addc_u32 s45, s45, 0
global_load_dwordx4 v[112:115], v8, s[44:45] nt
s_add_u32 s44, s44, 2048
 s_addc_u32 s45, s45, 0
global_load_dwordx4 v[116:119], v8, s[44:45] nt
global_load_dwordx4 v[56:59], v8, s[6:7] nt
s_add_u32 s6, s6, 2048
 s_addc_u32 s7, s7, 0
global_load_dwordx4 v[60:63], v8, s[6:7] nt
s_add_u32 s6, s6, 2048
 s_addc_u32 s7, s7, 0
global_load_dwordx4 v[64:67], v8, s[6:7] nt
s_add_u32 s6, s6, 2048
 s_addc_u32 s7, s7, 0
global_load_dwordx4 v[68:71], v8, s[6:7] nt
s_add_u32 s6, s6, 26624
 s_addc_u32 s7, s7, 0
global_load_dwordx4 v[72:75], v8, s[6:7] nt
s_add_u32 s6, s6, 2048
 s_addc_u32 s7, s7, 0
global_load_dwordx4 v[76:79], v8, s[6:7] nt
s_add_u32 s6, s6, 2048
 s_addc_u32 s7, s7, 0
global_load_dwordx4 v[80:83], v8, s[6:7] nt
s_add_u32 s6, s6, 2048
 s_addc_u32 s7, s7, 0
global_load_dwordx4 v[84:87], v8, s[6:7] nt
L_grd_33:

    s_lshl_b32 s61, s53, 7
    s_add_u32 s61, s61, 2752512
    v_and_b32 v7, 7, v0
    v_lshl_add_u32 v7, v7, 4, s61
    s_lshl_b32 s61, s53, 13
    s_lshl_b32 s62, s27, 10
    s_add_u32 s61, s61, s62
    s_add_u32 s61, s61, 2359296
    s_add_u32 s10, s24, s61
    s_addc_u32 s11, s25, 0
    s_lshl_b32 s61, s53, 12
    s_add_u32 s61, s61, s62
    s_add_u32 s61, s61, 2621440
    s_add_u32 s46, s24, s61
    s_addc_u32 s47, s25, 0
    v_lshrrev_b32 v8, 5, v0
    v_lshl_add_u32 v9, v8, 12, v1

s_cbranch_execz L_grd_34
s_waitcnt vmcnt(0)
L_grd_34:
v_perm_b32 v24, v92, v88, s37
v_perm_b32 v25, v100, v96, s37
v_perm_b32 v26, v108, v104, s37
v_perm_b32 v27, v116, v112, s37
v_perm_b32 v28, v92, v88, s38
v_perm_b32 v29, v100, v96, s38
v_perm_b32 v30, v108, v104, s38
v_perm_b32 v31, v116, v112, s38
v_perm_b32 v32, v93, v89, s37
v_perm_b32 v33, v101, v97, s37
v_perm_b32 v34, v109, v105, s37
v_perm_b32 v35, v117, v113, s37
v_perm_b32 v36, v93, v89, s38
v_perm_b32 v37, v101, v97, s38
v_perm_b32 v38, v109, v105, s38
v_perm_b32 v39, v117, v113, s38
v_perm_b32 v40, v94, v90, s37
v_perm_b32 v41, v102, v98, s37
v_perm_b32 v42, v110, v106, s37
v_perm_b32 v43, v118, v114, s37
v_perm_b32 v44, v94, v90, s38
v_perm_b32 v45, v102, v98, s38
v_perm_b32 v46, v110, v106, s38
v_perm_b32 v47, v118, v114, s38
v_perm_b32 v48, v95, v91, s37
v_perm_b32 v49, v103, v99, s37
v_perm_b32 v50, v111, v107, s37
v_perm_b32 v51, v119, v115, s37
v_perm_b32 v52, v95, v91, s38
v_perm_b32 v53, v103, v99, s38
v_perm_b32 v54, v111, v107, s38
v_perm_b32 v55, v119, v115, s38
v_perm_b32 v88, v60, v56, s37
v_perm_b32 v89, v68, v64, s37
v_perm_b32 v90, v76, v72, s37
v_perm_b32 v91, v84, v80, s37
v_perm_b32 v92, v60, v56, s38
v_perm_b32 v93, v68, v64, s38
v_perm_b32 v94, v76, v72, s38
v_perm_b32 v95, v84, v80, s38
v_perm_b32 v96, v61, v57, s37
v_perm_b32 v97, v69, v65, s37
v_perm_b32 v98, v77, v73, s37
v_perm_b32 v99, v85, v81, s37
v_perm_b32 v100, v61, v57, s38
v_perm_b32 v101, v69, v65, s38
v_perm_b32 v102, v77, v73, s38
v_perm_b32 v103, v85, v81, s38
v_perm_b32 v104, v62, v58, s37
v_perm_b32 v105, v70, v66, s37
v_perm_b32 v106, v78, v74, s37
v_perm_b32 v107, v86, v82, s37
v_perm_b32 v108, v62, v58, s38
v_perm_b32 v109, v70, v66, s38
v_perm_b32 v110, v78, v74, s38
v_perm_b32 v111, v86, v82, s38
v_perm_b32 v112, v63, v59, s37
v_perm_b32 v113, v71, v67, s37
v_perm_b32 v114, v79, v75, s37
v_perm_b32 v115, v87, v83, s37
v_perm_b32 v116, v63, v59, s38
v_perm_b32 v117, v71, v67, s38
v_perm_b32 v118, v79, v75, s38
v_perm_b32 v119, v87, v83, s38
s_mov_b32 s60, 0
s_cbranch_execz L_grd_40
global_load_dwordx4 v[16:19], v7, s[24:25] sc1
global_load_dwordx4 v[160:163], v7, s[24:25] sc1
L_grd_40:
L_hC_35:
s_cbranch_execz L_grd_41
global_load_dwordx4 v[164:167], v7, s[24:25] sc1
s_waitcnt vmcnt(2)
L_grd_41:
v_xor_b32 v20, s29, v16
v_xor_b32 v21, s30, v17
v_xor_b32 v22, s31, v18
v_xor_b32 v23, s32, v19
v_or3_b32 v20, v20, v21, v22
v_or_b32 v20, v20, v23
v_and_b32 v20, 0xff, v20
v_cmp_ne_u32 vcc, 0, v20
s_nop 0
s_cbranch_vccz L_hCk0_37
s_sleep 1
s_cbranch_execz L_grd_42
global_load_dwordx4 v[16:19], v7, s[24:25] sc1
s_waitcnt vmcnt(2)
L_grd_42:
v_xor_b32 v20, s29, v160
v_xor_b32 v21, s30, v161
v_xor_b32 v22, s31, v162
v_xor_b32 v23, s32, v163
v_or3_b32 v20, v20, v21, v22
v_or_b32 v20, v20, v23
v_and_b32 v20, 0xff, v20
v_cmp_ne_u32 vcc, 0, v20
s_nop 0
s_cbranch_vccz L_hCk1_38
s_sleep 1
s_cbranch_execz L_grd_43
global_load_dwordx4 v[160:163], v7, s[24:25] sc1
s_waitcnt vmcnt(2)
L_grd_43:
v_xor_b32 v20, s29, v164
v_xor_b32 v21, s30, v165
v_xor_b32 v22, s31, v166
v_xor_b32 v23, s32, v167
v_or3_b32 v20, v20, v21, v22
v_or_b32 v20, v20, v23
v_and_b32 v20, 0xff, v20
v_cmp_ne_u32 vcc, 0, v20
s_nop 0
s_cbranch_vccz L_hCk2_39
s_sleep 1
s_add_u32 s60, s60, 1
s_cmp_lt_u32 s60, 4000
s_cbranch_scc1 L_hC_35
s_branch L_abort
L_hCk0_37:
v_mov_b32 v156, v16
v_mov_b32 v157, v17
v_mov_b32 v158, v18
v_mov_b32 v159, v19
s_branch L_hCok_36
L_hCk1_38:
v_mov_b32 v156, v160
v_mov_b32 v157, v161
v_mov_b32 v158, v162
v_mov_b32 v159, v163
s_branch L_hCok_36
L_hCk2_39:
v_mov_b32 v156, v164
v_mov_b32 v157, v165
v_mov_b32 v158, v166
v_mov_b32 v159, v167
L_hCok_36:
s_mov_b32 s60, 0
s_cbranch_execz L_grd_47
global_load_dwordx4 v[120:123], v9, s[10:11] offset:0 sc1
global_load_dwordx4 v[124:127], v9, s[10:11] offset:512 sc1
global_load_dwordx4 v[128:131], v1, s[46:47] offset:0 sc1
global_load_dwordx4 v[132:135], v1, s[46:47] offset:512 sc1
L_grd_47:
v_add_f32_dpp v156, v156, v156 quad_perm:[1,0,3,2] row_mask:0xf bank_mask:0xf
v_add_f32_dpp v157, v157, v157 quad_perm:[1,0,3,2] row_mask:0xf bank_mask:0xf
v_add_f32_dpp v158, v158, v158 quad_perm:[1,0,3,2] row_mask:0xf bank_mask:0xf
v_add_f32_dpp v159, v159, v159 quad_perm:[1,0,3,2] row_mask:0xf bank_mask:0xf
v_add_f32_dpp v156, v156, v156 quad_perm:[2,3,0,1] row_mask:0xf bank_mask:0xf
v_add_f32_dpp v157, v157, v157 quad_perm:[2,3,0,1] row_mask:0xf bank_mask:0xf
v_add_f32_dpp v158, v158, v158 quad_perm:[2,3,0,1] row_mask:0xf bank_mask:0xf
v_add_f32_dpp v159, v159, v159 quad_perm:[2,3,0,1] row_mask:0xf bank_mask:0xf
v_add_f32_dpp v156, v156, v156 row_ror:4 row_mask:0xf bank_mask:0xf
v_add_f32_dpp v157, v157, v157 row_ror:4 row_mask:0xf bank_mask:0xf
v_add_f32_dpp v158, v158, v158 row_ror:4 row_mask:0xf bank_mask:0xf
v_add_f32_dpp v159, v159, v159 row_ror:4 row_mask:0xf bank_mask:0xf

        v_mul_f32 v156, 0x3a800000, v156
        v_mul_f32 v158, 0x3a800000, v158
        v_mul_f32 v157, 0x3a800000, v157
        v_mul_f32 v159, 0x3a800000, v159
        v_cndmask_b32 v152, v156, v158, s[40:41]
        v_fma_f32 v157, -v156, v156, v157
        v_fma_f32 v159, -v158, v158, v159
        v_max_f32 v157, 0, v157
        v_max_f32 v159, 0, v159
        v_add_f32 v157, 0x3727c5ac, v157
        v_add_f32 v159, 0x3727c5ac, v159
        v_rsq_f32 v153, v157
        v_rsq_f32 v154, v159
        s_nop 0
        v_cndmask_b32 v155, v153, v154, s[48:49]

s_branch L_gCc_45
L_gC_44:
s_cbranch_execz L_grd_48
global_load_dwordx4 v[120:123], v9, s[10:11] offset:0 sc1
global_load_dwordx4 v[124:127], v9, s[10:11] offset:512 sc1
global_load_dwordx4 v[128:131], v1, s[46:47] offset:0 sc1
global_load_dwordx4 v[132:135], v1, s[46:47] offset:512 sc1
L_grd_48:
L_gCc_45:
s_cbranch_execz L_grd_49
s_waitcnt vmcnt(0)
L_grd_49:
v_xor_b32 v20, s29, v120
v_xor_b32 v21, s30, v121
v_xor_b32 v22, s31, v122
v_xor_b32 v23, s32, v123
v_bitop3_b32 v20, v124, s29, v20 bitop3:0xbe
v_bitop3_b32 v21, v125, s30, v21 bitop3:0xbe
v_bitop3_b32 v22, v126, s31, v22 bitop3:0xbe
v_bitop3_b32 v23, v127, s32, v23 bitop3:0xbe
v_bitop3_b32 v20, v128, s29, v20 bitop3:0xbe
v_bitop3_b32 v21, v129, s30, v21 bitop3:0xbe
v_bitop3_b32 v22, v130, s31, v22 bitop3:0xbe
v_bitop3_b32 v23, v131, s32, v23 bitop3:0xbe
v_bitop3_b32 v20, v132, s29, v20 bitop3:0xbe
v_bitop3_b32 v21, v133, s30, v21 bitop3:0xbe
v_bitop3_b32 v22, v134, s31, v22 bitop3:0xbe
v_bitop3_b32 v23, v135, s32, v23 bitop3:0xbe
v_or3_b32 v20, v20, v21, v22
v_or_b32 v20, v20, v23
v_and_b32 v20, 0xff, v20
v_cmp_ne_u32 vcc, 0, v20
s_nop 0
s_cbranch_vccz L_gCok_46
s_add_u32 s60, s60, 1
s_sleep 1
s_cmp_lt_u32 s60, 4000
s_cbranch_scc1 L_gC_44
s_branch L_abort
L_gCok_46:
v_add_f32 v120, v120, v124
 v_add_f32 v128, v128, v132
v_add_f32 v121, v121, v125
 v_add_f32 v129, v129, v133
v_add_f32 v122, v122, v126
 v_add_f32 v130, v130, v134
v_add_f32 v123, v123, v127
 v_add_f32 v131, v131, v135
v_fma_f32 v120, -v152, v128, v120
v_fma_f32 v121, -v152, v129, v121
v_fma_f32 v122, -v152, v130, v122
v_fma_f32 v123, -v152, v131, v123
ds_write_b128 v11, v[120:123] offset:17920
s_waitcnt lgkmcnt(0)
s_cbranch_execz L_grd_50
s_barrier
L_grd_50:
ds_read_b64 v[140:141], v5 offset:17920
ds_read_b64 v[142:143], v5 offset:19008
ds_read_b64 v[144:145], v5 offset:20096
ds_read_b64 v[146:147], v5 offset:21184

        s_waitcnt lgkmcnt(2)
        v_pk_add_f32 v[140:141], v[140:141], v[142:143]
        s_waitcnt lgkmcnt(0)
        v_pk_add_f32 v[144:145], v[144:145], v[146:147]
        v_pk_add_f32 v[140:141], v[140:141], v[144:145]
        v_mul_f32 v140, v140, v155
        v_mul_f32 v141, v141, v155
        v_mul_f32 v142, 0xbfb8aa3b, v140
        v_mul_f32 v143, 0xbfb8aa3b, v141
        v_exp_f32 v142, v142
        v_exp_f32 v143, v143
        s_nop 0
        v_add_f32 v142, 1.0, v142
        v_add_f32 v143, 1.0, v143
        v_rcp_f32 v142, v142
        v_rcp_f32 v143, v143
        s_nop 0
        v_mul_f32 v140, v140, v142
        v_mul_f32 v141, v141, v143
        v_cvt_pk_bf16_f32 v144, v140, v141
        s_nop 1

v_mov_b32_dpp v16, v144 quad_perm:[0,0,0,0] row_mask:0xf bank_mask:0xf
v_mov_b32_dpp v17, v144 quad_perm:[1,1,1,1] row_mask:0xf bank_mask:0xf
v_mov_b32_dpp v18, v144 quad_perm:[2,2,2,2] row_mask:0xf bank_mask:0xf
v_mov_b32_dpp v19, v144 quad_perm:[3,3,3,3] row_mask:0xf bank_mask:0xf
s_nop 1
v_mfma_f32_16x16x32_bf16 v[120:123], v[16:19], v[24:27], 0
v_mfma_f32_16x16x32_bf16 v[124:127], v[16:19], v[28:31], 0
v_mfma_f32_16x16x32_bf16 v[128:131], v[16:19], v[32:35], 0
v_mfma_f32_16x16x32_bf16 v[132:135], v[16:19], v[36:39], 0
v_mfma_f32_16x16x32_bf16 v[136:139], v[16:19], v[40:43], 0
v_mfma_f32_16x16x32_bf16 v[140:143], v[16:19], v[44:47], 0
v_mfma_f32_16x16x32_bf16 v[144:147], v[16:19], v[48:51], 0
v_mfma_f32_16x16x32_bf16 v[148:151], v[16:19], v[52:55], 0
v_mfma_f32_16x16x32_bf16 v[56:59], v[16:19], v[88:91], 0
v_mfma_f32_16x16x32_bf16 v[60:63], v[16:19], v[92:95], 0
v_mfma_f32_16x16x32_bf16 v[64:67], v[16:19], v[96:99], 0
v_mfma_f32_16x16x32_bf16 v[68:71], v[16:19], v[100:103], 0
v_mfma_f32_16x16x32_bf16 v[72:75], v[16:19], v[104:107], 0
v_mfma_f32_16x16x32_bf16 v[76:79], v[16:19], v[108:111], 0
v_mfma_f32_16x16x32_bf16 v[80:83], v[16:19], v[112:115], 0
v_mfma_f32_16x16x32_bf16 v[84:87], v[16:19], v[116:119], 0
s_lshl_b32 s61, s27, 10
 v_lshl_add_u32 v7, v0, 4, s61
v_cndmask_b32 v20, v120, v136, s[40:41]
v_cndmask_b32 v21, v124, v140, s[40:41]
v_cndmask_b32 v22, v128, v144, s[40:41]
v_cndmask_b32 v23, v132, v148, s[40:41]
ds_write_b128 v7, v[20:23] offset:45312
v_cndmask_b32 v16, v56, v72, s[40:41]
v_cndmask_b32 v17, v60, v76, s[40:41]
v_cndmask_b32 v18, v64, v80, s[40:41]
v_cndmask_b32 v19, v68, v84, s[40:41]
ds_write_b128 v7, v[16:19] offset:49408
s_waitcnt lgkmcnt(0)
s_cbranch_execz L_grd_52
s_barrier
L_grd_52:

        s_cmp_ge_u32 s27, 2
        s_cbranch_scc1 L_noredc_51
        s_mul_i32 s61, s27, 4096
        v_lshl_add_u32 v7, v0, 4, s61
ds_read_b128 v[152:155], v7 offset:45312
ds_read_b128 v[156:159], v7 offset:46336
ds_read_b128 v[160:163], v7 offset:47360
ds_read_b128 v[164:167], v7 offset:48384

        s_and_b32 s61, s55, 3
        s_lshl_b32 s61, s61, 1
        s_add_u32 s61, s61, s27
        s_mul_i32 s61, s61, 56
        s_add_u32 s61, s61, s53
        s_lshl_b32 s61, s61, 9
        s_add_u32 s61, s61, 2883584
        v_and_b32 v7, 1, v2
        v_mul_u32_u24 v7, 14336, v7
        v_add3_u32 v7, v7, v10, s61
s_waitcnt lgkmcnt(0)
v_pk_add_f32 v[152:153], v[152:153], v[156:157]
 v_pk_add_f32 v[160:161], v[160:161], v[164:165]
v_pk_add_f32 v[154:155], v[154:155], v[158:159]
 v_pk_add_f32 v[162:163], v[162:163], v[166:167]
v_pk_add_f32 v[152:153], v[152:153], v[160:161]
v_pk_add_f32 v[154:155], v[154:155], v[162:163]
v_perm_b32 v20, v152, v6, s33
v_perm_b32 v21, v153, v6, s34
v_perm_b32 v22, v154, v6, s35
v_perm_b32 v23, v155, v6, s36
s_cbranch_execz L_grd_53
global_store_dwordx4 v7, v[20:23], s[24:25] sc1
L_grd_53:
L_noredc_51:
L_skipC1:
s_branch L_D
L_Y:
s_cbranch_execz L_grd_54
s_barrier
 s_barrier
L_grd_54:

    s_cmp_ge_u32 s59, 14
    s_cbranch_scc1 L_D

        s_lshl_b32 s61, s57, 7
        s_lshl_b32 s62, s27, 5
        s_add_u32 s61, s61, s62
        s_mul_i32 s61, s61, 7168
        s_lshl_b32 s62, s59, 9
        s_add_u32 s61, s61, s62

        s_add_u32 s44, s16, s61
        s_addc_u32 s45, s17, 0
        s_add_u32 s6, s44, 256
        s_addc_u32 s7, s45, 0

        v_mul_u32_u24 v8, 28672, v2
        v_lshl_add_u32 v8, v3, 4, v8
s_cbranch_execz L_grd_55
global_load_dwordx4 v[24:27], v8, s[44:45] nt
s_add_u32 s44, s44, 7168
 s_addc_u32 s45, s45, 0
global_load_dwordx4 v[28:31], v8, s[44:45] nt
s_add_u32 s44, s44, 7168
 s_addc_u32 s45, s45, 0
global_load_dwordx4 v[32:35], v8, s[44:45] nt
s_add_u32 s44, s44, 7168
 s_addc_u32 s45, s45, 0
global_load_dwordx4 v[36:39], v8, s[44:45] nt
s_add_u32 s44, s44, 93184
 s_addc_u32 s45, s45, 0
global_load_dwordx4 v[40:43], v8, s[44:45] nt
s_add_u32 s44, s44, 7168
 s_addc_u32 s45, s45, 0
global_load_dwordx4 v[44:47], v8, s[44:45] nt
s_add_u32 s44, s44, 7168
 s_addc_u32 s45, s45, 0
global_load_dwordx4 v[48:51], v8, s[44:45] nt
s_add_u32 s44, s44, 7168
 s_addc_u32 s45, s45, 0
global_load_dwordx4 v[52:55], v8, s[44:45] nt
global_load_dwordx4 v[56:59], v8, s[6:7] nt
s_add_u32 s6, s6, 7168
 s_addc_u32 s7, s7, 0
global_load_dwordx4 v[60:63], v8, s[6:7] nt
s_add_u32 s6, s6, 7168
 s_addc_u32 s7, s7, 0
global_load_dwordx4 v[64:67], v8, s[6:7] nt
s_add_u32 s6, s6, 7168
 s_addc_u32 s7, s7, 0
global_load_dwordx4 v[68:71], v8, s[6:7] nt
s_add_u32 s6, s6, 93184
 s_addc_u32 s7, s7, 0
global_load_dwordx4 v[72:75], v8, s[6:7] nt
s_add_u32 s6, s6, 7168
 s_addc_u32 s7, s7, 0
global_load_dwordx4 v[76:79], v8, s[6:7] nt
s_add_u32 s6, s6, 7168
 s_addc_u32 s7, s7, 0
global_load_dwordx4 v[80:83], v8, s[6:7] nt
s_add_u32 s6, s6, 7168
 s_addc_u32 s7, s7, 0
global_load_dwordx4 v[84:87], v8, s[6:7] nt
L_grd_55:

    s_lshl_b32 s61, s57, 15
    s_lshl_b32 s62, s27, 12
    s_add_u32 s61, s61, s62
    s_add_u32 s61, s61, 2097152
    s_add_u32 s10, s24, s61
    s_addc_u32 s11, s25, 0
    v_lshrrev_b32 v8, 5, v0
    v_lshl_add_u32 v9, v8, 14, v1

        v_bfe_u32 v8, v0, 3, 1
        v_and_b32 v7, 7, v0
        v_lshlrev_b32 v7, 9, v7
        v_lshl_add_u32 v7, v8, 14, v7

s_cbranch_execz L_grd_56
s_waitcnt vmcnt(0)
L_grd_56:
v_perm_b32 v88, v28, v24, s37
v_perm_b32 v89, v36, v32, s37
v_perm_b32 v90, v44, v40, s37
v_perm_b32 v91, v52, v48, s37
v_perm_b32 v92, v28, v24, s38
v_perm_b32 v93, v36, v32, s38
v_perm_b32 v94, v44, v40, s38
v_perm_b32 v95, v52, v48, s38
v_perm_b32 v96, v29, v25, s37
v_perm_b32 v97, v37, v33, s37
v_perm_b32 v98, v45, v41, s37
v_perm_b32 v99, v53, v49, s37
v_perm_b32 v100, v29, v25, s38
v_perm_b32 v101, v37, v33, s38
v_perm_b32 v102, v45, v41, s38
v_perm_b32 v103, v53, v49, s38
v_perm_b32 v104, v30, v26, s37
v_perm_b32 v105, v38, v34, s37
v_perm_b32 v106, v46, v42, s37
v_perm_b32 v107, v54, v50, s37
v_perm_b32 v108, v30, v26, s38
v_perm_b32 v109, v38, v34, s38
v_perm_b32 v110, v46, v42, s38
v_perm_b32 v111, v54, v50, s38
v_perm_b32 v112, v31, v27, s37
v_perm_b32 v113, v39, v35, s37
v_perm_b32 v114, v47, v43, s37
v_perm_b32 v115, v55, v51, s37
v_perm_b32 v116, v31, v27, s38
v_perm_b32 v117, v39, v35, s38
v_perm_b32 v118, v47, v43, s38
v_perm_b32 v119, v55, v51, s38
v_perm_b32 v24, v60, v56, s37
v_perm_b32 v25, v68, v64, s37
v_perm_b32 v26, v76, v72, s37
v_perm_b32 v27, v84, v80, s37
v_perm_b32 v28, v60, v56, s38
v_perm_b32 v29, v68, v64, s38
v_perm_b32 v30, v76, v72, s38
v_perm_b32 v31, v84, v80, s38
v_perm_b32 v32, v61, v57, s37
v_perm_b32 v33, v69, v65, s37
v_perm_b32 v34, v77, v73, s37
v_perm_b32 v35, v85, v81, s37
v_perm_b32 v36, v61, v57, s38
v_perm_b32 v37, v69, v65, s38
v_perm_b32 v38, v77, v73, s38
v_perm_b32 v39, v85, v81, s38
v_perm_b32 v40, v62, v58, s37
v_perm_b32 v41, v70, v66, s37
v_perm_b32 v42, v78, v74, s37
v_perm_b32 v43, v86, v82, s37
v_perm_b32 v44, v62, v58, s38
v_perm_b32 v45, v70, v66, s38
v_perm_b32 v46, v78, v74, s38
v_perm_b32 v47, v86, v82, s38
v_perm_b32 v48, v63, v59, s37
v_perm_b32 v49, v71, v67, s37
v_perm_b32 v50, v79, v75, s37
v_perm_b32 v51, v87, v83, s37
v_perm_b32 v52, v63, v59, s38
v_perm_b32 v53, v71, v67, s38
v_perm_b32 v54, v79, v75, s38
v_perm_b32 v55, v87, v83, s38
s_and_b32 exec_lo, s14, 0xffff
 s_and_b32 exec_hi, s15, 0
s_mov_b32 s60, 0
s_cbranch_execz L_grd_62
global_load_dwordx4 v[16:19], v7, s[10:11] sc1
global_load_dwordx4 v[160:163], v7, s[10:11] sc1
L_grd_62:
L_hB_57:
s_cbranch_execz L_grd_63
global_load_dwordx4 v[164:167], v7, s[10:11] sc1
s_waitcnt vmcnt(2)
L_grd_63:
v_xor_b32 v20, s29, v16
v_xor_b32 v21, s30, v17
v_xor_b32 v22, s31, v18
v_xor_b32 v23, s32, v19
v_or3_b32 v20, v20, v21, v22
v_or_b32 v20, v20, v23
v_and_b32 v20, 0xff, v20
v_cmp_ne_u32 vcc, 0, v20
s_nop 0
s_cbranch_vccz L_hBk0_59
s_sleep 1
s_cbranch_execz L_grd_64
global_load_dwordx4 v[16:19], v7, s[10:11] sc1
s_waitcnt vmcnt(2)
L_grd_64:
v_xor_b32 v20, s29, v160
v_xor_b32 v21, s30, v161
v_xor_b32 v22, s31, v162
v_xor_b32 v23, s32, v163
v_or3_b32 v20, v20, v21, v22
v_or_b32 v20, v20, v23
v_and_b32 v20, 0xff, v20
v_cmp_ne_u32 vcc, 0, v20
s_nop 0
s_cbranch_vccz L_hBk1_60
s_sleep 1
s_cbranch_execz L_grd_65
global_load_dwordx4 v[160:163], v7, s[10:11] sc1
s_waitcnt vmcnt(2)
L_grd_65:
v_xor_b32 v20, s29, v164
v_xor_b32 v21, s30, v165
v_xor_b32 v22, s31, v166
v_xor_b32 v23, s32, v167
v_or3_b32 v20, v20, v21, v22
v_or_b32 v20, v20, v23
v_and_b32 v20, 0xff, v20
v_cmp_ne_u32 vcc, 0, v20
s_nop 0
s_cbranch_vccz L_hBk2_61
s_sleep 1
s_add_u32 s60, s60, 1
s_cmp_lt_u32 s60, 4000
s_cbranch_scc1 L_hB_57
s_branch L_abort
L_hBk0_59:
s_branch L_hBok_58
L_hBk1_60:
s_branch L_hBok_58
L_hBk2_61:
L_hBok_58:
s_mov_b64 exec, s[14:15]
s_mov_b32 s60, 0
s_cbranch_execz L_grd_69
global_load_dwordx4 v[120:123], v9, s[10:11] offset:0 sc1
global_load_dwordx4 v[124:127], v9, s[10:11] offset:512 sc1
global_load_dwordx4 v[128:131], v9, s[10:11] offset:1024 sc1
global_load_dwordx4 v[132:135], v9, s[10:11] offset:1536 sc1
global_load_dwordx4 v[136:139], v9, s[10:11] offset:2048 sc1
global_load_dwordx4 v[140:143], v9, s[10:11] offset:2560 sc1
global_load_dwordx4 v[144:147], v9, s[10:11] offset:3072 sc1
global_load_dwordx4 v[148:151], v9, s[10:11] offset:3584 sc1
L_grd_69:
s_branch L_gBc_67
L_gB_66:
s_cbranch_execz L_grd_70
global_load_dwordx4 v[120:123], v9, s[10:11] offset:0 sc1
global_load_dwordx4 v[124:127], v9, s[10:11] offset:512 sc1
global_load_dwordx4 v[128:131], v9, s[10:11] offset:1024 sc1
global_load_dwordx4 v[132:135], v9, s[10:11] offset:1536 sc1
global_load_dwordx4 v[136:139], v9, s[10:11] offset:2048 sc1
global_load_dwordx4 v[140:143], v9, s[10:11] offset:2560 sc1
global_load_dwordx4 v[144:147], v9, s[10:11] offset:3072 sc1
global_load_dwordx4 v[148:151], v9, s[10:11] offset:3584 sc1
L_grd_70:
L_gBc_67:
s_cbranch_execz L_grd_71
s_waitcnt vmcnt(0)
L_grd_71:
v_xor_b32 v20, s29, v120
v_xor_b32 v21, s30, v121
v_xor_b32 v22, s31, v122
v_xor_b32 v23, s32, v123
v_bitop3_b32 v20, v124, s29, v20 bitop3:0xbe
v_bitop3_b32 v21, v125, s30, v21 bitop3:0xbe
v_bitop3_b32 v22, v126, s31, v22 bitop3:0xbe
v_bitop3_b32 v23, v127, s32, v23 bitop3:0xbe
v_bitop3_b32 v20, v128, s29, v20 bitop3:0xbe
v_bitop3_b32 v21, v129, s30, v21 bitop3:0xbe
v_bitop3_b32 v22, v130, s31, v22 bitop3:0xbe
v_bitop3_b32 v23, v131, s32, v23 bitop3:0xbe
v_bitop3_b32 v20, v132, s29, v20 bitop3:0xbe
v_bitop3_b32 v21, v133, s30, v21 bitop3:0xbe
v_bitop3_b32 v22, v134, s31, v22 bitop3:0xbe
v_bitop3_b32 v23, v135, s32, v23 bitop3:0xbe
v_bitop3_b32 v20, v136, s29, v20 bitop3:0xbe
v_bitop3_b32 v21, v137, s30, v21 bitop3:0xbe
v_bitop3_b32 v22, v138, s31, v22 bitop3:0xbe
v_bitop3_b32 v23, v139, s32, v23 bitop3:0xbe
v_bitop3_b32 v20, v140, s29, v20 bitop3:0xbe
v_bitop3_b32 v21, v141, s30, v21 bitop3:0xbe
v_bitop3_b32 v22, v142, s31, v22 bitop3:0xbe
v_bitop3_b32 v23, v143, s32, v23 bitop3:0xbe
v_bitop3_b32 v20, v144, s29, v20 bitop3:0xbe
v_bitop3_b32 v21, v145, s30, v21 bitop3:0xbe
v_bitop3_b32 v22, v146, s31, v22 bitop3:0xbe
v_bitop3_b32 v23, v147, s32, v23 bitop3:0xbe
v_bitop3_b32 v20, v148, s29, v20 bitop3:0xbe
v_bitop3_b32 v21, v149, s30, v21 bitop3:0xbe
v_bitop3_b32 v22, v150, s31, v22 bitop3:0xbe
v_bitop3_b32 v23, v151, s32, v23 bitop3:0xbe
v_or3_b32 v20, v20, v21, v22
v_or_b32 v20, v20, v23
v_and_b32 v20, 0xff, v20
v_cmp_ne_u32 vcc, 0, v20
s_nop 0
s_cbranch_vccz L_gBok_68
s_add_u32 s60, s60, 1
s_sleep 1
s_cmp_lt_u32 s60, 4000
s_cbranch_scc1 L_gB_66
s_branch L_abort
L_gBok_68:
v_pk_add_f32 v[120:121], v[120:121], v[124:125]
 v_pk_add_f32 v[122:123], v[122:123], v[126:127]
v_pk_add_f32 v[128:129], v[128:129], v[132:133]
 v_pk_add_f32 v[130:131], v[130:131], v[134:135]
v_pk_add_f32 v[136:137], v[136:137], v[140:141]
 v_pk_add_f32 v[138:139], v[138:139], v[142:143]
v_pk_add_f32 v[144:145], v[144:145], v[148:149]
 v_pk_add_f32 v[146:147], v[146:147], v[150:151]
v_pk_add_f32 v[120:121], v[120:121], v[128:129]
 v_pk_add_f32 v[122:123], v[122:123], v[130:131]
v_pk_add_f32 v[136:137], v[136:137], v[144:145]
 v_pk_add_f32 v[138:139], v[138:139], v[146:147]
v_pk_add_f32 v[120:121], v[120:121], v[136:137]
 v_pk_add_f32 v[122:123], v[122:123], v[138:139]
ds_write_b128 v11, v[120:123] offset:12544
v_lshlrev_b32 v160, 16, v12
 v_and_b32 v161, 0xffff0000, v12
s_waitcnt lgkmcnt(0)
s_cbranch_execz L_grd_72
s_barrier
L_grd_72:
ds_read_b64 v[140:141], v5 offset:12544
ds_read_b64 v[142:143], v5 offset:13632
ds_read_b64 v[144:145], v5 offset:14720
ds_read_b64 v[146:147], v5 offset:15808
v_mov_b32 v20, 0x3f803f80

        s_waitcnt lgkmcnt(2)
        v_pk_add_f32 v[140:141], v[140:141], v[142:143]
        s_waitcnt lgkmcnt(0)
        v_pk_add_f32 v[144:145], v[144:145], v[146:147]
        v_pk_add_f32 v[140:141], v[140:141], v[144:145]
v_pk_add_f32 v[140:141], v[160:161], v[140:141]
v_cvt_pk_bf16_f32 v144, v140, v141
 s_nop 1
v_mov_b32_dpp v12, v144 quad_perm:[0,0,0,0] row_mask:0xf bank_mask:0xf
v_mov_b32_dpp v13, v144 quad_perm:[1,1,1,1] row_mask:0xf bank_mask:0xf
v_mov_b32_dpp v14, v144 quad_perm:[2,2,2,2] row_mask:0xf bank_mask:0xf
v_mov_b32_dpp v15, v144 quad_perm:[3,3,3,3] row_mask:0xf bank_mask:0xf
s_nop 0
v_cndmask_b32 v16, v12, v20, s[50:51]
v_cndmask_b32 v17, v13, v20, s[50:51]
v_cndmask_b32 v18, v14, v20, s[50:51]
v_cndmask_b32 v19, v15, v20, s[50:51]
s_nop 1
v_mfma_f32_16x16x32_bf16 v[164:167], v[16:19], v[16:19], 0
v_mfma_f32_16x16x32_bf16 v[120:123], v[16:19], v[88:91], 0
v_mfma_f32_16x16x32_bf16 v[124:127], v[16:19], v[92:95], 0
v_mfma_f32_16x16x32_bf16 v[128:131], v[16:19], v[96:99], 0
v_mfma_f32_16x16x32_bf16 v[132:135], v[16:19], v[100:103], 0
v_mfma_f32_16x16x32_bf16 v[136:139], v[16:19], v[104:107], 0
v_mfma_f32_16x16x32_bf16 v[140:143], v[16:19], v[108:111], 0
v_mfma_f32_16x16x32_bf16 v[144:147], v[16:19], v[112:115], 0
v_mfma_f32_16x16x32_bf16 v[148:151], v[16:19], v[116:119], 0
v_mfma_f32_16x16x32_bf16 v[56:59], v[16:19], v[24:27], 0
v_mfma_f32_16x16x32_bf16 v[60:63], v[16:19], v[28:31], 0
v_mfma_f32_16x16x32_bf16 v[64:67], v[16:19], v[32:35], 0
v_mfma_f32_16x16x32_bf16 v[68:71], v[16:19], v[36:39], 0
v_mfma_f32_16x16x32_bf16 v[72:75], v[16:19], v[40:43], 0
v_mfma_f32_16x16x32_bf16 v[76:79], v[16:19], v[44:47], 0
v_mfma_f32_16x16x32_bf16 v[80:83], v[16:19], v[48:51], 0
v_mfma_f32_16x16x32_bf16 v[84:87], v[16:19], v[52:55], 0

    s_lshl_b32 s61, s27, 10
    v_lshl_add_u32 v7, v0, 4, s61
    v_lshrrev_b32 v8, 4, v0
    v_lshlrev_b32 v8, 3, v8
    v_not_b32 v9, v0
    v_and_b32 v9, 1, v9
    v_lshl_add_u32 v8, v9, 2, v8
    s_lshl_b32 s61, s27, 4
    v_add_u32 v8, s61, v8

v_cndmask_b32 v20, v120, v136, s[40:41]
v_cndmask_b32 v21, v124, v140, s[40:41]
v_cndmask_b32 v22, v128, v144, s[40:41]
v_cndmask_b32 v23, v132, v148, s[40:41]
ds_write_b128 v7, v[20:23] offset:28928
v_cndmask_b32 v16, v121, v137, s[40:41]
v_cndmask_b32 v17, v125, v141, s[40:41]
v_cndmask_b32 v18, v129, v145, s[40:41]
v_cndmask_b32 v19, v133, v149, s[40:41]
ds_write_b128 v7, v[16:19] offset:45312
v_cndmask_b32 v152, v56, v72, s[40:41]
v_cndmask_b32 v153, v60, v76, s[40:41]
v_cndmask_b32 v154, v64, v80, s[40:41]
v_cndmask_b32 v155, v68, v84, s[40:41]
ds_write_b128 v7, v[152:155] offset:33024
v_cndmask_b32 v156, v57, v73, s[40:41]
v_cndmask_b32 v157, v61, v77, s[40:41]
v_cndmask_b32 v158, v65, v81, s[40:41]
v_cndmask_b32 v159, v69, v85, s[40:41]
ds_write_b128 v7, v[156:159] offset:49408
s_and_b32 exec_lo, s14, 0x00300003
 s_and_b32 exec_hi, s15, 0
ds_write_b32 v8, v164 offset:16896
s_mov_b64 exec, s[14:15]
s_waitcnt lgkmcnt(0)
s_cbranch_execz L_grd_73
s_barrier
L_grd_73:

    s_cmp_eq_u32 s27, 3
    s_cbranch_scc1 L_b_st
    s_cmp_eq_u32 s27, 2
    s_cbranch_scc1 L_b_cs
    s_mul_i32 s61, s27, 4096
    v_lshl_add_u32 v7, v0, 4, s61

ds_read_b128 v[136:139], v7 offset:28928
ds_read_b128 v[140:143], v7 offset:29952
ds_read_b128 v[144:147], v7 offset:30976
ds_read_b128 v[148:151], v7 offset:32000

    s_lshl_b32 s61, s59, 1
    s_add_u32 s61, s61, s27
    s_lshl_b32 s61, s61, 4
    s_add_u32 s61, s61, s57
    s_lshl_b32 s61, s61, 9
    s_add_u32 s61, s61, 2359296
    v_and_b32 v7, 1, v2
    v_lshl_add_u32 v7, v7, 12, v10
    v_add_u32 v7, s61, v7
    s_waitcnt lgkmcnt(0)
v_pk_add_f32 v[136:137], v[136:137], v[140:141]
 v_pk_add_f32 v[144:145], v[144:145], v[148:149]
v_pk_add_f32 v[138:139], v[138:139], v[142:143]
 v_pk_add_f32 v[146:147], v[146:147], v[150:151]
v_pk_add_f32 v[136:137], v[136:137], v[144:145]
v_pk_add_f32 v[138:139], v[138:139], v[146:147]
v_perm_b32 v20, v136, v6, s33
v_perm_b32 v21, v137, v6, s34
v_perm_b32 v22, v138, v6, s35
v_perm_b32 v23, v139, v6, s36
s_cbranch_execz L_grd_74
global_store_dwordx4 v7, v[20:23], s[24:25] sc1
L_grd_74:

    s_branch L_b_done
    L_b_cs:
    v_and_b32 v8, 1, v2
    v_mul_u32_u24 v7, 4096, v8
    v_lshl_add_u32 v7, v0, 4, v7

ds_read_b128 v[136:139], v7 offset:45312
ds_read_b128 v[140:143], v7 offset:46336
ds_read_b128 v[144:147], v7 offset:47360
ds_read_b128 v[148:151], v7 offset:48384

    s_lshl_b32 s61, s59, 4
    s_add_u32 s61, s61, s57
    s_lshl_b32 s61, s61, 9
    s_add_u32 s61, s61, 2621440
    v_lshl_add_u32 v7, v8, 12, v10
    v_add_u32 v7, s61, v7
    s_waitcnt lgkmcnt(0)
v_pk_add_f32 v[136:137], v[136:137], v[140:141]
 v_pk_add_f32 v[144:145], v[144:145], v[148:149]
v_pk_add_f32 v[138:139], v[138:139], v[142:143]
 v_pk_add_f32 v[146:147], v[146:147], v[150:151]
v_pk_add_f32 v[136:137], v[136:137], v[144:145]
v_pk_add_f32 v[138:139], v[138:139], v[146:147]
v_perm_b32 v20, v136, v6, s33
v_perm_b32 v21, v137, v6, s34
v_perm_b32 v22, v138, v6, s35
v_perm_b32 v23, v139, v6, s36
s_cbranch_execz L_grd_75
global_store_dwordx4 v7, v[20:23], s[24:25] sc1
L_grd_75:

    s_branch L_b_done
    L_b_st:
    v_mov_b32 v7, 0

ds_read_b128 v[136:139], v7 offset:16896
ds_read_b128 v[140:143], v7 offset:16912
ds_read_b128 v[144:147], v7 offset:16928
ds_read_b128 v[148:151], v7 offset:16944

    s_lshl_b32 s61, s59, 4
    s_add_u32 s61, s61, s57
    s_lshl_b32 s61, s61, 4
    s_add_u32 s61, s61, 2752512
    v_lshl_add_u32 v7, v0, 7, s61
    s_waitcnt lgkmcnt(0)

v_pk_add_f32 v[136:137], v[136:137], v[140:141]
 v_pk_add_f32 v[144:145], v[144:145], v[148:149]
v_pk_add_f32 v[138:139], v[138:139], v[142:143]
 v_pk_add_f32 v[146:147], v[146:147], v[150:151]
v_pk_add_f32 v[136:137], v[136:137], v[144:145]
v_pk_add_f32 v[138:139], v[138:139], v[146:147]
v_perm_b32 v20, v136, v6, s33
v_perm_b32 v21, v137, v6, s34
v_perm_b32 v22, v138, v6, s35
v_perm_b32 v23, v139, v6, s36
s_and_b32 exec_lo, s14, 3
 s_and_b32 exec_hi, s15, 0
s_cbranch_execz L_grd_76
global_store_dwordx4 v7, v[20:23], s[24:25] sc1
L_grd_76:
s_mov_b64 exec, s[14:15]
L_b_done:

    s_cmp_lg_u32 s59, 0
    s_cbranch_scc1 L_nohp
v_lshlrev_b32 v152, 16, v12
 v_and_b32 v153, 0xffff0000, v12
v_lshlrev_b32 v154, 16, v13
 v_and_b32 v155, 0xffff0000, v13
v_lshlrev_b32 v156, 16, v14
 v_and_b32 v157, 0xffff0000, v14
v_lshlrev_b32 v158, 16, v15
 v_and_b32 v159, 0xffff0000, v15
v_perm_b32 v124, v152, v6, s33
v_perm_b32 v125, v153, v6, s34
v_perm_b32 v126, v154, v6, s35
v_perm_b32 v127, v155, v6, s36
v_perm_b32 v128, v156, v6, s33
v_perm_b32 v129, v157, v6, s34
v_perm_b32 v130, v158, v6, s35
v_perm_b32 v131, v159, v6, s36

    s_lshl_b32 s61, s57, 5
    s_lshl_b32 s62, s27, 3
    s_add_u32 s61, s61, s62
    s_lshl_b32 s61, s61, 4
    s_add_u32 s61, s61, 589824
    v_lshlrev_b32 v8, 4, v2
    v_lshl_add_u32 v8, v4, 12, v8
    v_add_u32 v8, s61, v8
s_and_b32 exec_lo, s14, 0x00110011
 s_and_b32 exec_hi, s15, 0x00110011
s_cbranch_execz L_grd_77
global_store_dwordx4 v8, v[124:127], s[24:25] sc1
    global_store_dwordx4 v8, v[128:131], s[24:25] offset:64 sc1
L_grd_77:
s_mov_b64 exec, s[14:15]
L_nohp:
L_D:

    s_cmp_lg_u32 s27, 0
    s_cbranch_scc1 L_G_done
    s_and_b32 s4, s2, 7
    s_lshl_b32 s4, s4, 5
    s_lshr_b32 s5, s2, 3
    s_add_u32 s4, s4, s5
    s_lshr_b32 s44, s4, 7
    s_bfe_u32 s45, s4, 0x30004
    s_and_b32 s46, s4, 15
    s_lshl_b32 s46, s46, 5
    s_lshl_b32 s61, s45, 1
    s_add_u32 s61, s61, s44
    s_mul_i32 s61, s61, 14336
    s_add_u32 s61, s61, s46
    s_add_u32 s61, s61, 2883584
    v_lshrrev_b32 v7, 1, v0
    v_lshlrev_b32 v7, 9, v7
    v_and_b32 v8, 1, v0
    v_lshl_add_u32 v7, v8, 4, v7
    v_add_u32 v7, s61, v7
    s_lshl_b32 s61, s44, 12
    s_lshl_b32 s62, s45, 9
    s_add_u32 s61, s61, s62
    s_add_u32 s61, s61, s46
    s_add_u32 s61, s61, 589824
    v_lshl_add_u32 v9, v8, 4, s61
    v_cmp_le_u32 vcc, 56, v0
    s_nop 1
    v_cndmask_b32 v7, v7, v9, vcc

s_and_b32 exec_lo, s14, -1
 s_and_b32 exec_hi, s15, 0x03ffffff
s_cbranch_execz L_grd_78
s_sleep 12
L_grd_78:
s_mov_b32 s60, 0
s_cbranch_execz L_grd_84
global_load_dwordx4 v[120:123], v7, s[24:25] sc1
s_sleep 3
global_load_dwordx4 v[124:127], v7, s[24:25] sc1
s_sleep 3
L_grd_84:
L_gd_79:
s_cbranch_execz L_grd_85
global_load_dwordx4 v[128:131], v7, s[24:25] sc1
s_waitcnt vmcnt(2)
L_grd_85:
v_xor_b32 v20, s29, v120
v_xor_b32 v21, s30, v121
v_xor_b32 v22, s31, v122
v_xor_b32 v23, s32, v123
v_or3_b32 v20, v20, v21, v22
v_or_b32 v20, v20, v23
v_and_b32 v20, 0xff, v20
v_cmp_ne_u32 vcc, 0, v20
s_nop 0
s_cbranch_vccz L_gdk0_81
s_sleep 1
s_cbranch_execz L_grd_86
global_load_dwordx4 v[120:123], v7, s[24:25] sc1
s_waitcnt vmcnt(2)
L_grd_86:
v_xor_b32 v20, s29, v124
v_xor_b32 v21, s30, v125
v_xor_b32 v22, s31, v126
v_xor_b32 v23, s32, v127
v_or3_b32 v20, v20, v21, v22
v_or_b32 v20, v20, v23
v_and_b32 v20, 0xff, v20
v_cmp_ne_u32 vcc, 0, v20
s_nop 0
s_cbranch_vccz L_gdk1_82
s_sleep 1
s_cbranch_execz L_grd_87
global_load_dwordx4 v[124:127], v7, s[24:25] sc1
s_waitcnt vmcnt(2)
L_grd_87:
v_xor_b32 v20, s29, v128
v_xor_b32 v21, s30, v129
v_xor_b32 v22, s31, v130
v_xor_b32 v23, s32, v131
v_or3_b32 v20, v20, v21, v22
v_or_b32 v20, v20, v23
v_and_b32 v20, 0xff, v20
v_cmp_ne_u32 vcc, 0, v20
s_nop 0
s_cbranch_vccz L_gdk2_83
s_sleep 1
s_add_u32 s60, s60, 1
s_cmp_lt_u32 s60, 4000
s_cbranch_scc1 L_gd_79
s_branch L_abort
L_gdk0_81:
v_mov_b32 v132, v120
v_mov_b32 v133, v121
v_mov_b32 v134, v122
v_mov_b32 v135, v123
s_branch L_gdok_80
L_gdk1_82:
v_mov_b32 v132, v124
v_mov_b32 v133, v125
v_mov_b32 v134, v126
v_mov_b32 v135, v127
s_branch L_gdok_80
L_gdk2_83:
v_mov_b32 v132, v128
v_mov_b32 v133, v129
v_mov_b32 v134, v130
v_mov_b32 v135, v131
L_gdok_80:
s_mov_b64 exec, s[14:15]
s_and_b32 exec_lo, s14, 0
 s_and_b32 exec_hi, s15, 0xfc000000
v_mov_b32 v132, 0
v_mov_b32 v133, 0
v_mov_b32 v134, 0
v_mov_b32 v135, 0
s_mov_b64 exec, s[14:15]
v_add_f32_dpp v132, v132, v132 quad_perm:[2,3,0,1] row_mask:0xf bank_mask:0xf
v_add_f32_dpp v133, v133, v133 quad_perm:[2,3,0,1] row_mask:0xf bank_mask:0xf
v_add_f32_dpp v134, v134, v134 quad_perm:[2,3,0,1] row_mask:0xf bank_mask:0xf
v_add_f32_dpp v135, v135, v135 quad_perm:[2,3,0,1] row_mask:0xf bank_mask:0xf
v_add_f32_dpp v132, v132, v132 row_ror:4 row_mask:0xf bank_mask:0xf
v_add_f32_dpp v133, v133, v133 row_ror:4 row_mask:0xf bank_mask:0xf
v_add_f32_dpp v134, v134, v134 row_ror:4 row_mask:0xf bank_mask:0xf
v_add_f32_dpp v135, v135, v135 row_ror:4 row_mask:0xf bank_mask:0xf
v_add_f32_dpp v132, v132, v132 row_ror:8 row_mask:0xf bank_mask:0xf
v_add_f32_dpp v133, v133, v133 row_ror:8 row_mask:0xf bank_mask:0xf
v_add_f32_dpp v134, v134, v134 row_ror:8 row_mask:0xf bank_mask:0xf
v_add_f32_dpp v135, v135, v135 row_ror:8 row_mask:0xf bank_mask:0xf
v_mov_b32 v136, v132
v_mov_b32 v137, v133
v_mov_b32 v138, v134
v_mov_b32 v139, v135
s_nop 0
v_permlane16_swap_b32 v132, v136
v_permlane16_swap_b32 v133, v137
v_permlane16_swap_b32 v134, v138
v_permlane16_swap_b32 v135, v139
s_nop 0
v_add_f32 v132, v132, v136
v_add_f32 v133, v133, v137
v_add_f32 v134, v134, v138
v_add_f32 v135, v135, v139
v_mov_b32 v136, v132
v_mov_b32 v137, v133
v_mov_b32 v138, v134
v_mov_b32 v139, v135
s_nop 0
v_permlane32_swap_b32 v132, v136
v_permlane32_swap_b32 v133, v137
v_permlane32_swap_b32 v134, v138
v_permlane32_swap_b32 v135, v139
s_nop 0
v_add_f32 v132, v132, v136
v_add_f32 v133, v133, v137
v_add_f32 v134, v134, v138
v_add_f32 v135, v135, v139

    v_cvt_pk_bf16_f32 v140, v132, v133
    v_cvt_pk_bf16_f32 v141, v134, v135
    s_lshl_b32 s61, s4, 4
    v_lshl_add_u32 v7, v8, 3, s61

s_and_b32 exec_lo, s14, 3
 s_and_b32 exec_hi, s15, 0
s_cbranch_execz L_grd_88
global_store_dwordx2 v7, v[140:141], s[20:21]
L_grd_88:

    s_cmp_lg_u32 s2, 0
    s_cbranch_scc1 L_G_done

s_mov_b64 exec, s[14:15]
v_mov_b32 v7, 0
s_and_b32 exec_lo, s14, 1
 s_and_b32 exec_hi, s15, 0
s_cbranch_execz L_grd_89
global_store_dword v7, v6, s[24:25] sc1
L_grd_89:
L_G_done:
s_cbranch_execz L_dry_done
s_endpgm

    L_A:
    s_setprio 2
    s_sub_u32 s27, s26, 4
    s_and_b32 s52, s2, 7
    s_lshr_b32 s53, s2, 3
    s_lshl_b32 s61, s52, 22
    s_lshl_b32 s62, s53, 17
    s_add_u32 s61, s61, s62
    s_lshl_b32 s62, s27, 12
    s_add_u32 s61, s61, s62
    s_lshl_b32 s62, s27, 14

v_add_u32 v10, 0, v2
 v_xor_b32 v10, v10, v3
 v_lshlrev_b32 v10, 4, v10
 v_lshl_add_u32 v5, v2, 8, v10
v_add_u32 v10, 4, v2
 v_xor_b32 v10, v10, v3
 v_lshlrev_b32 v10, 4, v10
 v_lshl_add_u32 v6, v2, 8, v10
v_add_u32 v10, 8, v2
 v_xor_b32 v10, v10, v3
 v_lshlrev_b32 v10, 4, v10
 v_lshl_add_u32 v7, v2, 8, v10
v_add_u32 v10, 12, v2
 v_xor_b32 v10, v10, v3
 v_lshlrev_b32 v10, 4, v10
 v_lshl_add_u32 v8, v2, 8, v10

    v_lshlrev_b32 v10, 4, v3
    v_lshl_add_u32 v9, v2, 10, v10
    v_mov_b32 v11, 0
    s_mov_b32 s42, 0xff00ff00
    s_mov_b32 s43, 0xff00ff00
    s_waitcnt lgkmcnt(0)
    s_add_u32 s44, s6, s61
    s_addc_u32 s45, s7, 0
    s_add_u32 s46, s8, s61
    s_addc_u32 s47, s9, 0
    s_add_u32 m0, s62, 8192
    s_barrier
    global_load_dword v4, v11, s[24:25] sc1

global_load_lds_dwordx4 v5, s[44:45] offset:0 nt
global_load_lds_dwordx4 v6, s[44:45] offset:1024 nt
global_load_lds_dwordx4 v7, s[44:45] offset:2048 nt
s_waitcnt vmcnt(2)
global_load_lds_dwordx4 v8, s[44:45] offset:3072 nt
s_add_u32 s44, s44, 32768
 s_addc_u32 s45, s45, 0
 s_add_u32 m0, m0, 4096
s_waitcnt vmcnt(2)
global_load_lds_dwordx4 v5, s[44:45] offset:0 nt
s_waitcnt vmcnt(2)
global_load_lds_dwordx4 v6, s[44:45] offset:1024 nt
s_waitcnt vmcnt(2)
global_load_lds_dwordx4 v7, s[44:45] offset:2048 nt
s_waitcnt vmcnt(2)
global_load_lds_dwordx4 v8, s[44:45] offset:3072 nt
s_add_u32 s44, s44, 32768
 s_addc_u32 s45, s45, 0
 s_add_u32 m0, m0, 4096
s_waitcnt vmcnt(2)
global_load_lds_dwordx4 v5, s[44:45] offset:0 nt
s_waitcnt vmcnt(2)
global_load_lds_dwordx4 v6, s[44:45] offset:1024 nt
s_waitcnt vmcnt(2)
global_load_lds_dwordx4 v7, s[44:45] offset:2048 nt
s_waitcnt vmcnt(2)
global_load_lds_dwordx4 v8, s[44:45] offset:3072 nt
s_add_u32 s44, s44, 32768
 s_addc_u32 s45, s45, 0
 s_add_u32 m0, m0, 4096
s_waitcnt vmcnt(2)
global_load_lds_dwordx4 v5, s[44:45] offset:0 nt
s_waitcnt vmcnt(2)
global_load_lds_dwordx4 v6, s[44:45] offset:1024 nt
s_waitcnt vmcnt(2)
global_load_lds_dwordx4 v7, s[44:45] offset:2048 nt
s_waitcnt vmcnt(2)
global_load_lds_dwordx4 v8, s[44:45] offset:3072 nt
s_setprio 1
global_load_dwordx4 v[16:19], v9, s[46:47] offset:0 nt
global_load_dwordx4 v[20:23], v9, s[46:47] offset:256 nt
global_load_dwordx4 v[24:27], v9, s[46:47] offset:512 nt
global_load_dwordx4 v[28:31], v9, s[46:47] offset:768 nt
s_add_u32 s46, s46, 32768
 s_addc_u32 s47, s47, 0
global_load_dwordx4 v[32:35], v9, s[46:47] offset:0 nt
global_load_dwordx4 v[36:39], v9, s[46:47] offset:256 nt
global_load_dwordx4 v[40:43], v9, s[46:47] offset:512 nt
global_load_dwordx4 v[44:47], v9, s[46:47] offset:768 nt
s_add_u32 s46, s46, 32768
 s_addc_u32 s47, s47, 0
global_load_dwordx4 v[48:51], v9, s[46:47] offset:0 nt
global_load_dwordx4 v[52:55], v9, s[46:47] offset:256 nt
global_load_dwordx4 v[56:59], v9, s[46:47] offset:512 nt
global_load_dwordx4 v[60:63], v9, s[46:47] offset:768 nt
s_add_u32 s46, s46, 32768
 s_addc_u32 s47, s47, 0
global_load_dwordx4 v[64:67], v9, s[46:47] offset:0 nt
global_load_dwordx4 v[68:71], v9, s[46:47] offset:256 nt
global_load_dwordx4 v[72:75], v9, s[46:47] offset:512 nt
global_load_dwordx4 v[76:79], v9, s[46:47] offset:768 nt

    v_mov_b32 v11, 0
    v_mov_b32 v12, 1
    s_mov_b64 exec, 1
    ds_add_u32 v11, v12 offset:6916
    s_mov_b64 exec, -1
s_lshl_b32 s61, s27, 14
 s_add_u32 s61, s61, 8192
v_add_u32 v10, 0, v2
 v_xor_b32 v10, v10, v3
 v_lshlrev_b32 v10, 4, v10
 v_lshl_add_u32 v10, v3, 8, v10
 v_add_u32 v5, s61, v10
v_add_u32 v10, 4, v2
 v_xor_b32 v10, v10, v3
 v_lshlrev_b32 v10, 4, v10
 v_lshl_add_u32 v10, v3, 8, v10
 v_add_u32 v6, s61, v10
v_add_u32 v10, 8, v2
 v_xor_b32 v10, v10, v3
 v_lshlrev_b32 v10, 4, v10
 v_lshl_add_u32 v10, v3, 8, v10
 v_add_u32 v7, s61, v10
v_add_u32 v10, 12, v2
 v_xor_b32 v10, v10, v3
 v_lshlrev_b32 v10, 4, v10
 v_lshl_add_u32 v10, v3, 8, v10
 v_add_u32 v8, s61, v10

        s_mov_b32 s60, 0
        s_cbranch_execz L_Aqok_91
        L_Aq_90:
        ds_read_b32 v12, v11 offset:6912
        s_waitcnt lgkmcnt(0)
        v_readfirstlane_b32 s61, v12
        s_cmp_ge_u32 s61, 4
        s_cbranch_scc1 L_Aqok_91
        s_add_u32 s60, s60, 1
s_sleep 4

        s_cmp_lt_u32 s60, 400000
        s_cbranch_scc1 L_Aq_90
        s_branch L_abort
        L_Aqok_91:

    v_and_b32 v10, 7, v3
    v_mul_u32_u24 v10, 272, v10
    v_lshl_add_u32 v10, v2, 4, v10

ds_read_b128 v[80:83], v10 offset:0
ds_read_b128 v[84:87], v10 offset:64
ds_read_b128 v[88:91], v10 offset:128
ds_read_b128 v[92:95], v10 offset:192
s_waitcnt vmcnt(16)

        v_readfirstlane_b32 s28, v4
        s_add_u32 s28, s28, 0x01010101
        s_or_b32 s28, s28, 1
        s_mov_b32 s29, s28
        s_lshr_b32 s30, s28, 8
        s_lshr_b32 s31, s28, 16
        s_lshr_b32 s32, s28, 24
        v_mov_b32 v4, s28

ds_read_b128 v[96:99], v5 offset:0
ds_read_b128 v[100:103], v6 offset:0
ds_read_b128 v[104:107], v7 offset:0
ds_read_b128 v[108:111], v8 offset:0
ds_read_b128 v[112:115], v5 offset:4096
ds_read_b128 v[116:119], v6 offset:4096
ds_read_b128 v[120:123], v7 offset:4096
ds_read_b128 v[124:127], v8 offset:4096
s_waitcnt lgkmcnt(4)
v_mfma_f32_16x16x32_bf16 v[128:131], v[96:99], v[80:83], 0
v_mfma_f32_16x16x32_bf16 v[128:131], v[100:103], v[84:87], v[128:131]
v_mfma_f32_16x16x32_bf16 v[128:131], v[104:107], v[88:91], v[128:131]
v_mfma_f32_16x16x32_bf16 v[128:131], v[108:111], v[92:95], v[128:131]
ds_read_b128 v[96:99], v5 offset:8192
ds_read_b128 v[100:103], v6 offset:8192
ds_read_b128 v[104:107], v7 offset:8192
ds_read_b128 v[108:111], v8 offset:8192
s_waitcnt lgkmcnt(4)
v_mfma_f32_16x16x32_bf16 v[132:135], v[112:115], v[80:83], 0
v_mfma_f32_16x16x32_bf16 v[132:135], v[116:119], v[84:87], v[132:135]
v_mfma_f32_16x16x32_bf16 v[132:135], v[120:123], v[88:91], v[132:135]
v_mfma_f32_16x16x32_bf16 v[132:135], v[124:127], v[92:95], v[132:135]
ds_read_b128 v[112:115], v5 offset:12288
ds_read_b128 v[116:119], v6 offset:12288
ds_read_b128 v[120:123], v7 offset:12288
ds_read_b128 v[124:127], v8 offset:12288
s_waitcnt lgkmcnt(4)
v_mfma_f32_16x16x32_bf16 v[136:139], v[96:99], v[80:83], 0
v_mfma_f32_16x16x32_bf16 v[136:139], v[100:103], v[84:87], v[136:139]
v_mfma_f32_16x16x32_bf16 v[136:139], v[104:107], v[88:91], v[136:139]
v_mfma_f32_16x16x32_bf16 v[136:139], v[108:111], v[92:95], v[136:139]
s_waitcnt lgkmcnt(0)
v_mfma_f32_16x16x32_bf16 v[140:143], v[112:115], v[80:83], 0
v_mfma_f32_16x16x32_bf16 v[140:143], v[116:119], v[84:87], v[140:143]
v_mfma_f32_16x16x32_bf16 v[140:143], v[120:123], v[88:91], v[140:143]
v_mfma_f32_16x16x32_bf16 v[140:143], v[124:127], v[92:95], v[140:143]
s_nop 7
v_max3_f32 v13, v128, v129, v130
v_max3_f32 v13, v13, v131, v132
v_max3_f32 v13, v13, v133, v134
v_max3_f32 v13, v13, v135, v136
v_max3_f32 v13, v13, v137, v138
v_max3_f32 v13, v13, v139, v140
v_max3_f32 v13, v13, v141, v142
v_max_f32 v13, v13, v143
v_mov_b32 v12, v13
s_nop 1
v_permlane16_swap_b32 v13, v12
s_nop 1
v_max_f32 v13, v13, v12
v_mov_b32 v12, v13
s_nop 1
v_permlane32_swap_b32 v13, v12
s_nop 1
v_max_f32 v13, v13, v12

    s_mov_b32 s39, 0x3e0293ee
    v_mul_f32 v13, s39, v13
v_fma_f32 v128, v128, s39, -v13
v_fma_f32 v129, v129, s39, -v13
v_fma_f32 v130, v130, s39, -v13
v_fma_f32 v131, v131, s39, -v13
v_fma_f32 v132, v132, s39, -v13
v_fma_f32 v133, v133, s39, -v13
v_fma_f32 v134, v134, s39, -v13
v_fma_f32 v135, v135, s39, -v13
v_fma_f32 v136, v136, s39, -v13
v_fma_f32 v137, v137, s39, -v13
v_fma_f32 v138, v138, s39, -v13
v_fma_f32 v139, v139, s39, -v13
v_fma_f32 v140, v140, s39, -v13
v_fma_f32 v141, v141, s39, -v13
v_fma_f32 v142, v142, s39, -v13
v_fma_f32 v143, v143, s39, -v13
v_exp_f32 v128, v128
v_exp_f32 v129, v129
v_exp_f32 v130, v130
v_exp_f32 v131, v131
v_exp_f32 v132, v132
v_exp_f32 v133, v133
v_exp_f32 v134, v134
v_exp_f32 v135, v135
v_exp_f32 v136, v136
v_exp_f32 v137, v137
v_exp_f32 v138, v138
v_exp_f32 v139, v139
v_exp_f32 v140, v140
v_exp_f32 v141, v141
v_exp_f32 v142, v142
v_exp_f32 v143, v143
s_nop 0
v_cvt_pk_bf16_f32 v144, v128, v129
v_cvt_pk_bf16_f32 v145, v130, v131
v_cvt_pk_bf16_f32 v146, v132, v133
v_cvt_pk_bf16_f32 v147, v134, v135
v_cvt_pk_bf16_f32 v148, v136, v137
v_cvt_pk_bf16_f32 v149, v138, v139
v_cvt_pk_bf16_f32 v150, v140, v141
v_cvt_pk_bf16_f32 v151, v142, v143
v_add_f32 v14, v128, v129
v_add_f32 v14, v14, v130
v_add_f32 v14, v14, v131
v_add_f32 v14, v14, v132
v_add_f32 v14, v14, v133
v_add_f32 v14, v14, v134
v_add_f32 v14, v14, v135
v_add_f32 v14, v14, v136
v_add_f32 v14, v14, v137
v_add_f32 v14, v14, v138
v_add_f32 v14, v14, v139
v_add_f32 v14, v14, v140
v_add_f32 v14, v14, v141
v_add_f32 v14, v14, v142
v_add_f32 v14, v14, v143
v_mov_b32 v96, v14
s_nop 1
v_permlane16_swap_b32 v14, v96
s_nop 1
v_add_f32 v14, v14, v96
v_mov_b32 v96, v14
s_nop 1
v_permlane32_swap_b32 v14, v96
s_nop 1
v_add_f32 v14, v14, v96

    v_and_b32 v10, 7, v3
    v_lshlrev_b32 v10, 5, v10
    s_lshl_b32 s61, s27, 2
    v_add_u32 v10, s61, v10
    s_mov_b64 exec, 0xff
    ds_write_b32 v10, v13 offset:2304
    ds_write_b32 v10, v14 offset:2560
    s_mov_b64 exec, 1
    v_mov_b32 v11, 0
    v_mov_b32 v12, 1
    s_waitcnt lgkmcnt(0)
    ds_add_rtn_u32 v12, v11, v12 offset:6920
    s_waitcnt lgkmcnt(0)
    s_mov_b64 exec, -1
    v_readfirstlane_b32 s61, v12
    s_mov_b32 s60, 0
    s_cmp_lg_u32 s61, 7
    s_cbranch_scc1 L_A_noml
    v_and_b32 v10, 7, v0
    v_lshlrev_b32 v11, 5, v10
    ds_read_b128 v[96:99], v11 offset:2304
    ds_read_b128 v[100:103], v11 offset:2320
    ds_read_b128 v[104:107], v11 offset:2560
    ds_read_b128 v[108:111], v11 offset:2576
    s_lshl_b32 s61, s52, 8
    s_add_u32 s61, s61, s53
    s_lshl_b32 s61, s61, 4
    s_add_u32 s61, s61, 524288
    v_lshl_add_u32 v11, v10, 9, s61
    s_waitcnt lgkmcnt(0)
    v_max3_f32 v112, v96, v97, v98
    v_max3_f32 v113, v99, v100, v101
    v_max3_f32 v112, v112, v102, v103
    v_max_f32 v112, v112, v113
    v_perm_b32 v112, v112, v4, s33

v_sub_f32 v96, v96, v112
v_sub_f32 v97, v97, v112
v_sub_f32 v98, v98, v112
v_sub_f32 v99, v99, v112
v_sub_f32 v100, v100, v112
v_sub_f32 v101, v101, v112
v_sub_f32 v102, v102, v112
v_sub_f32 v103, v103, v112
v_exp_f32 v96, v96
v_exp_f32 v97, v97
v_exp_f32 v98, v98
v_exp_f32 v99, v99
v_exp_f32 v100, v100
v_exp_f32 v101, v101
v_exp_f32 v102, v102
v_exp_f32 v103, v103
s_nop 0
 v_mul_f32 v113, v96, v104
v_fmac_f32 v113, v97, v105
v_fmac_f32 v113, v98, v106
v_fmac_f32 v113, v99, v107
v_fmac_f32 v113, v100, v108
v_fmac_f32 v113, v101, v109
v_fmac_f32 v113, v102, v110
v_fmac_f32 v113, v103, v111
v_mov_b32 v114, v112
 v_mov_b32 v115, v112
v_perm_b32 v116, v112, v4, s33
v_perm_b32 v117, v113, v4, s34
v_perm_b32 v118, v114, v4, s35
v_perm_b32 v119, v115, v4, s36

    s_mov_b64 exec, 0xff
    global_store_dwordx4 v11, v[116:119], s[24:25] sc1
    s_mov_b64 exec, -1
    s_mov_b32 s63, 1
    s_branch L_A_ml2
    L_A_noml:
    s_mov_b32 s63, 0
    L_A_ml2:

s_waitcnt vmcnt(8)
v_perm_b32 v80, v20, v16, s37
v_perm_b32 v81, v28, v24, s37
v_perm_b32 v82, v36, v32, s37
v_perm_b32 v83, v44, v40, s37
v_perm_b32 v84, v20, v16, s38
v_perm_b32 v85, v28, v24, s38
v_perm_b32 v86, v36, v32, s38
v_perm_b32 v87, v44, v40, s38
v_perm_b32 v88, v21, v17, s37
v_perm_b32 v89, v29, v25, s37
v_perm_b32 v90, v37, v33, s37
v_perm_b32 v91, v45, v41, s37
v_perm_b32 v92, v21, v17, s38
v_perm_b32 v93, v29, v25, s38
v_perm_b32 v94, v37, v33, s38
v_perm_b32 v95, v45, v41, s38
v_mfma_f32_16x16x32_bf16 v[112:115], v[80:83], v[144:147], 0
v_mfma_f32_16x16x32_bf16 v[116:119], v[84:87], v[144:147], 0
v_perm_b32 v96, v22, v18, s37
v_perm_b32 v97, v30, v26, s37
v_perm_b32 v98, v38, v34, s37
v_perm_b32 v99, v46, v42, s37
v_perm_b32 v100, v22, v18, s38
v_perm_b32 v101, v30, v26, s38
v_perm_b32 v102, v38, v34, s38
v_perm_b32 v103, v46, v42, s38
v_mfma_f32_16x16x32_bf16 v[120:123], v[88:91], v[144:147], 0
v_mfma_f32_16x16x32_bf16 v[124:127], v[92:95], v[144:147], 0
v_perm_b32 v104, v23, v19, s37
v_perm_b32 v105, v31, v27, s37
v_perm_b32 v106, v39, v35, s37
v_perm_b32 v107, v47, v43, s37
v_perm_b32 v108, v23, v19, s38
v_perm_b32 v109, v31, v27, s38
v_perm_b32 v110, v39, v35, s38
v_perm_b32 v111, v47, v43, s38
v_mfma_f32_16x16x32_bf16 v[128:131], v[96:99], v[144:147], 0
v_mfma_f32_16x16x32_bf16 v[132:135], v[100:103], v[144:147], 0
s_nop 1
v_mfma_f32_16x16x32_bf16 v[136:139], v[104:107], v[144:147], 0
v_mfma_f32_16x16x32_bf16 v[140:143], v[108:111], v[144:147], 0

    s_lshl_b32 s61, s27, 14
    s_add_u32 s61, s61, 8192
    v_mul_u32_u24 v10, 17, v2
    v_add_u32 v10, v10, v3
    v_lshl_add_u32 v10, v10, 4, s61
    v_bfe_u32 v11, v0, 3, 2
    v_and_b32 v5, 3, v0
    v_bfe_u32 v6, v0, 2, 1
    v_lshl_add_u32 v5, v5, 1, v6
    v_and_b32 v6, 3, v5
    v_lshrrev_b32 v5, 2, v5
    v_lshl_add_u32 v11, v6, 2, v11
    v_mul_u32_u24 v11, 17, v11
    v_lshl_add_u32 v11, v5, 3, v11
    v_add_u32 v11, s27, v11
    v_lshlrev_b32 v11, 4, v11
    v_lshrrev_b32 v5, 5, v0
    v_lshl_add_u32 v11, v5, 16, v11
    v_add_u32 v11, 8192, v11
    s_lshl_b32 s61, s27, 5
    v_lshl_add_u32 v6, v5, 4, s61
    v_xor_b32 v7, 16, v6
    s_lshl_b32 s61, s52, 3
    s_add_u32 s61, s61, s27
    s_lshl_b32 s61, s61, 5
    s_add_u32 s61, s61, s53
    s_lshl_b32 s62, s61, 9
    s_add_u32 s62, s62, 1048576
    v_and_b32 v8, 31, v0
    v_lshl_add_u32 v9, v8, 4, s62
    v_mov_b32 v5, 0

        s_mov_b32 s60, 0
        s_cbranch_execz L_Amxok_93
        L_Amx_92:
        ds_read_b32 v12, v5 offset:6920
        s_waitcnt lgkmcnt(0)
        v_readfirstlane_b32 s61, v12
        s_cmp_ge_u32 s61, 8
        s_cbranch_scc1 L_Amxok_93
        s_add_u32 s60, s60, 1
s_sleep 1

        s_cmp_lt_u32 s60, 400000
        s_cbranch_scc1 L_Amx_92
        s_branch L_abort
        L_Amxok_93:

    ds_read_b128 v[16:19], v6 offset:2304
    ds_read_b128 v[20:23], v7 offset:2304
    s_setprio 3
    s_waitcnt lgkmcnt(0)
    v_max3_f32 v13, v16, v17, v18
    v_max3_f32 v20, v20, v21, v22
    v_max3_f32 v13, v13, v19, v23
    v_max_f32 v13, v13, v20
    v_perm_b32 v13, v13, v4, s33

v_sub_f32 v16, v16, v13
v_sub_f32 v17, v17, v13
v_sub_f32 v18, v18, v13
v_sub_f32 v19, v19, v13
v_exp_f32 v16, v16
v_exp_f32 v17, v17
v_exp_f32 v18, v18
v_exp_f32 v19, v19
s_cmp_eq_u32 s63, 0
 s_cbranch_scc1 L_pw_94
 s_waitcnt vmcnt(5)
 s_branch L_pw_95
 L_pw_94:
 s_waitcnt vmcnt(4)
 L_pw_95:
v_perm_b32 v80, v52, v48, s37
v_perm_b32 v81, v60, v56, s37
v_perm_b32 v84, v52, v48, s38
v_perm_b32 v85, v60, v56, s38
v_perm_b32 v88, v53, v49, s37
v_perm_b32 v89, v61, v57, s37
v_perm_b32 v92, v53, v49, s38
v_perm_b32 v93, v61, v57, s38
v_perm_b32 v96, v54, v50, s37
v_perm_b32 v97, v62, v58, s37
v_perm_b32 v100, v54, v50, s38
v_perm_b32 v101, v62, v58, s38
v_perm_b32 v104, v55, v51, s37
v_perm_b32 v105, v63, v59, s37
v_perm_b32 v108, v55, v51, s38
v_perm_b32 v109, v63, v59, s38
s_cmp_eq_u32 s63, 0
 s_cbranch_scc1 L_pw_96
 s_waitcnt vmcnt(1)
 s_branch L_pw_97
 L_pw_96:
 s_waitcnt vmcnt(0)
 L_pw_97:
v_perm_b32 v82, v68, v64, s37
v_perm_b32 v83, v76, v72, s37
v_perm_b32 v86, v68, v64, s38
v_perm_b32 v87, v76, v72, s38
v_perm_b32 v90, v69, v65, s37
v_perm_b32 v91, v77, v73, s37
v_perm_b32 v94, v69, v65, s38
v_perm_b32 v95, v77, v73, s38
v_mfma_f32_16x16x32_bf16 v[112:115], v[80:83], v[148:151], v[112:115]
v_mfma_f32_16x16x32_bf16 v[116:119], v[84:87], v[148:151], v[116:119]
v_perm_b32 v98, v70, v66, s37
v_perm_b32 v99, v78, v74, s37
v_perm_b32 v102, v70, v66, s38
v_perm_b32 v103, v78, v74, s38
v_mfma_f32_16x16x32_bf16 v[120:123], v[88:91], v[148:151], v[120:123]
v_mfma_f32_16x16x32_bf16 v[124:127], v[92:95], v[148:151], v[124:127]
v_perm_b32 v106, v71, v67, s37
v_perm_b32 v107, v79, v75, s37
v_perm_b32 v110, v71, v67, s38
v_perm_b32 v111, v79, v75, s38
v_mfma_f32_16x16x32_bf16 v[128:131], v[96:99], v[148:151], v[128:131]
v_mfma_f32_16x16x32_bf16 v[132:135], v[100:103], v[148:151], v[132:135]
s_nop 1
v_mfma_f32_16x16x32_bf16 v[136:139], v[104:107], v[148:151], v[136:139]
v_mfma_f32_16x16x32_bf16 v[140:143], v[108:111], v[148:151], v[140:143]
s_nop 3
v_cndmask_b32 v80, v112, v128, s[42:43]
v_cndmask_b32 v81, v113, v129, s[42:43]
v_cndmask_b32 v82, v114, v130, s[42:43]
v_cndmask_b32 v83, v115, v131, s[42:43]
ds_write_b128 v10, v[80:83] offset:0
v_cndmask_b32 v84, v116, v132, s[42:43]
v_cndmask_b32 v85, v117, v133, s[42:43]
v_cndmask_b32 v86, v118, v134, s[42:43]
v_cndmask_b32 v87, v119, v135, s[42:43]
ds_write_b128 v10, v[84:87] offset:1088
s_nop 1
v_cndmask_b32 v88, v120, v136, s[42:43]
v_cndmask_b32 v89, v121, v137, s[42:43]
v_cndmask_b32 v90, v122, v138, s[42:43]
v_cndmask_b32 v91, v123, v139, s[42:43]
ds_write_b128 v10, v[88:91] offset:2176
v_cndmask_b32 v92, v124, v140, s[42:43]
v_cndmask_b32 v93, v125, v141, s[42:43]
v_cndmask_b32 v94, v126, v142, s[42:43]
v_cndmask_b32 v95, v127, v143, s[42:43]
ds_write_b128 v10, v[92:95] offset:3264
s_waitcnt lgkmcnt(0)

        s_cmp_ge_u32 s27, 4
        s_cbranch_scc1 L_A_b3
        s_mov_b64 exec, 0
        s_branch L_A_post
        L_A_postret:
        s_mov_b64 exec, -1
        L_A_b3:

s_barrier
L_A_post:
ds_read_b128 v[96:99], v11 offset:0
ds_read_b128 v[100:103], v11 offset:16384
ds_read_b128 v[104:107], v11 offset:32768
ds_read_b128 v[108:111], v11 offset:49152
s_waitcnt lgkmcnt(2)
v_mul_f32 v96, v96, v16
v_mul_f32 v97, v97, v16
v_mul_f32 v98, v98, v16
v_mul_f32 v99, v99, v16
v_fmac_f32 v96, v100, v17
v_fmac_f32 v97, v101, v17
v_fmac_f32 v98, v102, v17
v_fmac_f32 v99, v103, v17
s_waitcnt lgkmcnt(0)
v_fmac_f32 v96, v104, v18
v_fmac_f32 v97, v105, v18
v_fmac_f32 v98, v106, v18
v_fmac_f32 v99, v107, v18
v_fmac_f32 v96, v108, v19
v_fmac_f32 v97, v109, v19
v_fmac_f32 v98, v110, v19
v_fmac_f32 v99, v111, v19
v_mov_b32 v100, v96
v_mov_b32 v101, v97
v_mov_b32 v102, v98
v_mov_b32 v103, v99
s_nop 0
v_permlane32_swap_b32 v96, v100
v_permlane32_swap_b32 v97, v101
v_permlane32_swap_b32 v98, v102
v_permlane32_swap_b32 v99, v103
s_nop 0
v_add_f32 v96, v96, v100
v_add_f32 v97, v97, v101
v_add_f32 v98, v98, v102
v_add_f32 v99, v99, v103
v_perm_b32 v104, v96, v4, s33
v_perm_b32 v105, v97, v4, s34
v_perm_b32 v106, v98, v4, s35
v_perm_b32 v107, v99, v4, s36
s_mov_b32 exec_hi, 0
s_cbranch_execz L_grd_98
global_store_dwordx4 v9, v[104:107], s[24:25] sc1
L_grd_98:
s_cbranch_execz L_A_postret
s_barrier
s_endpgm

    L_abort:
    L_end:
    s_endpgm

.section .rodata,"a"
.p2align 6
.amdhsa_kernel sequential_preLN__gqa_block_cached__dense_activation_silu__decode_kernel
  .amdhsa_next_free_vgpr 168
  .amdhsa_next_free_sgpr 102
  .amdhsa_accum_offset 168
  .amdhsa_group_segment_fixed_size 0
  .amdhsa_kernarg_size 88
  .amdhsa_user_sgpr_count 2
  .amdhsa_user_sgpr_kernarg_segment_ptr 1
  .amdhsa_system_sgpr_workgroup_id_x 1
  .amdhsa_float_denorm_mode_32 3
.end_amdhsa_kernel
```
